```python
import torch

def _softmax(x, axis=-1):
    return torch.softmax(x, dim=axis)
def _gelu(x):
    return torch.nn.functional.gelu(x, approximate="tanh")
def _silu(x):
    return torch.nn.functional.silu(x)
def _sigmoid(x):
    return torch.sigmoid(x)
def _layernorm(x, axis=-1, eps=1e-5):
    m = x.mean(dim=axis, keepdim=True)
    v = x.var(dim=axis, keepdim=True, unbiased=False)
    return (x - m) / torch.sqrt(v + eps)
def _scatter_add(tgt, idx, src, axis=0):
    return tgt.clone().index_add_(axis, idx, src)
def _segment_sum(src, seg, n):
    out = torch.zeros((n,) + src.shape[1:], dtype=src.dtype)
    return out.index_add_(0, seg, src)
def _pad(x, pw):
    flat = tuple(v for pair in reversed(pw) for v in pair)
    return torch.nn.functional.pad(x, flat)

kernel_name = 'recurrent_scan__gqa_block_cached__glu_gated_reglu__decode'

def setup_inputs():

    _w = (lambda a: (lambda t: t.to(torch.bfloat16) if t.is_floating_point() else t)(torch.as_tensor(a)))
    def _A_setup():
        B, Sq, D = 2, 1, 512
        Hq, Hkv, Sk, Dh = 32, 8, 32768, 128
        assert Hq % Hkv == 0, (Hq, Hkv)
        return {
            "x": _w((lambda *s: torch.randn(*s, dtype=torch.bfloat16) * 0.4)(B, Sq, D)),
            "k_cache": _w((lambda *s: torch.randn(*s, dtype=torch.bfloat16) * 1.6)(B, Hkv, Sk, Dh)),
            "v_cache": _w((lambda *s: torch.randn(*s, dtype=torch.bfloat16) * 1.6)(B, Hkv, Sk, Dh)),
            "wq": _w((lambda *s: torch.randn(*s, dtype=torch.bfloat16) * 1.6)(D, Hq * Dh) * (D ** -0.5)),
            "wo": _w((lambda *s: torch.randn(*s, dtype=torch.bfloat16) * 1.6)(Hq * Dh, D) * ((Hq * Dh) ** -0.5)),
        }
    _A_in = _A_setup()

    def _B_setup():
        B, S, D, F = 2, 1, 512, 1792
        return {
            "x": _w((lambda *s: torch.randn(*s, dtype=torch.bfloat16) * 0.4)(B, S, D)),
            "W_gate": _w((lambda *s: torch.randn(*s, dtype=torch.bfloat16) * 1.6)(D, F) * (2.0 / D) ** 0.5),
            "W_up": _w((lambda *s: torch.randn(*s, dtype=torch.bfloat16) * 1.6)(D, F) * (2.0 / D) ** 0.5),
            "W_down": _w((lambda *s: torch.randn(*s, dtype=torch.bfloat16) * 1.6)(F, D) * (1.0 / F) ** 0.5),
        }
    _B_in = _B_setup()

    return {
        "A_x": _A_in["x"],
        "A_k_cache": _A_in["k_cache"],
        "A_v_cache": _A_in["v_cache"],
        "A_wq": _A_in["wq"],
        "A_wo": _A_in["wo"],
        "B_x": _B_in["x"],
        "B_W_gate": _B_in["W_gate"],
        "B_W_up": _B_in["W_up"],
        "B_W_down": _B_in["W_down"],
    }

def reference(A_x, A_k_cache, A_v_cache, A_wq, A_wo, B_x, B_W_gate, B_W_up, B_W_down):
    def _A_ref(x, k_cache, v_cache, wq, wo):
        B, Sq, D = x.shape
        Hq, Dh = 32, 128
        Hkv = k_cache.shape[1]
        rep = Hq // Hkv
        q = (lambda x, *d: x.permute(*d))((x @ wq).reshape(B, Sq, Hq, Dh), 0, 2, 1, 3)
        k = (lambda x, n, axis: torch.repeat_interleave(x, n, dim=axis))(k_cache, rep, axis=1)
        v = (lambda x, n, axis: torch.repeat_interleave(x, n, dim=axis))(v_cache, rep, axis=1)
        scores = torch.einsum("bhqd,bhkd->bhqk", q, k) * (Dh ** -0.5)
        p = _softmax(scores, axis=-1)
        o = torch.einsum("bhqk,bhkd->bhqd", p, v)
        return (lambda x, *d: x.permute(*d))(o, 0, 2, 1, 3).reshape(B, Sq, Hq * Dh) @ wo

    def _B_ref(x, W_gate, W_up, W_down):
        gate = torch.einsum("bsd,df->bsf", x, W_gate)
        up = torch.einsum("bsd,df->bsf", x, W_up)
        gate = gate * (lambda x, dt: x.to(dt))(gate > 0, gate.dtype)
        h = gate * up
        return torch.einsum("bsf,fd->bsd", h, W_down)

    x = A_x
    xn = _layernorm(x, axis=-1)
    s = _A_ref(xn, A_k_cache, A_v_cache, A_wq, A_wo)
    g = _silu(_B_ref(xn, B_W_gate, B_W_up, B_W_down))
    return x + s * g
```

```asm
; @launch grid=(256,1,1) block=(512,1,1) lds=66560
.amdgcn_target "amdgcn-amd-amdhsa--gfx950"
.text
.globl recurrent_scan__gqa_block_cached__glu_gated_reglu__decode_kernel
.p2align 8
.type recurrent_scan__gqa_block_cached__glu_gated_reglu__decode_kernel,@function
recurrent_scan__gqa_block_cached__glu_gated_reglu__decode_kernel:
    s_load_dwordx2 s[36:37], s[0:1], 8
    s_load_dwordx16 s[8:23], s[0:1], 0
    s_load_dwordx8 s[24:31], s[0:1], 64
    s_cmpk_ge_u32 s2, 0x100
    s_cbranch_scc1 L_exit
    v_lshrrev_b32 v4, 6, v0
    s_mov_b32 s39, 0x20000
    v_cmp_lt_u32 vcc, 3, v4
    s_cbranch_vccnz L_aux
    s_lshl_b32 s55, s2, 11
    s_and_b32 s55, s55, 0x58000
    s_mul_i32 s42, s2, 0x808000
    s_and_b32 s42, s42, 0x7e00000
    s_or_b32 s42, s42, s55
    s_lshl_b32 s38, 1, 27
    v_and_b32 v13, 3, v0
    v_lshlrev_b32 v13, 4, v13
    v_and_b32 v5, 12, v0
    v_lshl_add_u32 v14, v5, 6, v13
    v_and_b32 v5, 48, v0
    v_lshl_add_u32 v14, v5, 2, v14
    v_lshl_add_u32 v14, v4, 11, v14
    s_waitcnt lgkmcnt(0)
    buffer_load_dwordx4 v[96:99], v14, s[36:39], s42 offen offset:0 nt
    buffer_load_dwordx4 v[100:103], v14, s[36:39], s42 offen offset:1024 nt
    s_xor_b32 s43, s42, 0x2000
    buffer_load_dwordx4 v[104:107], v14, s[36:39], s43 offen offset:0 nt
    buffer_load_dwordx4 v[108:111], v14, s[36:39], s43 offen offset:1024 nt
    s_xor_b32 s43, s42, 0x4000
    buffer_load_dwordx4 v[112:115], v14, s[36:39], s43 offen offset:0 nt
    buffer_load_dwordx4 v[116:119], v14, s[36:39], s43 offen offset:1024 nt
    s_xor_b32 s43, s42, 0x6000
    s_barrier
    buffer_load_dwordx4 v[120:123], v14, s[36:39], s43 offen offset:0 nt
    buffer_load_dwordx4 v[124:127], v14, s[36:39], s43 offen offset:1024 nt
    s_xor_b32 s43, s42, 0x20000
    s_waitcnt vmcnt(6)
    buffer_load_dwordx4 v[128:131], v14, s[36:39], s43 offen offset:0 nt
    buffer_load_dwordx4 v[132:135], v14, s[36:39], s43 offen offset:1024 nt
    s_xor_b32 s43, s42, 0x22000
    s_waitcnt vmcnt(6)
    buffer_load_dwordx4 v[136:139], v14, s[36:39], s43 offen offset:0 nt
    buffer_load_dwordx4 v[140:143], v14, s[36:39], s43 offen offset:1024 nt
    s_xor_b32 s43, s42, 0x24000
    v_and_b32 v1, 63, v0
    v_readfirstlane_b32 s3, v4
    s_and_b32 s32, s2, 7
    v_lshrrev_b32 v2, 4, v1
    s_and_b32 s4, s3, 3
    v_and_b32 v3, 15, v1
    s_and_b32 s35, s2, 15
    s_lshr_b32 s33, s35, 3
    s_lshr_b32 s34, s2, 4
    s_cmp_gt_u32 s35, 11
    s_subb_u32 s56, s35, 0
    s_cmp_gt_u32 s35, 13
    s_subb_u32 s56, s56, 0
    s_lshr_b32 s57, s34, 3
    s_sub_u32 s94, 2, s57
    s_add_u32 s57, s57, 2
    s_lshl_b32 s95, s56, s57
    s_and_b32 s57, s34, 7
    s_add_u32 s95, s95, s57
    s_lshr_b32 s5, s34, 2
    s_cmp_eq_u32 s5, 1
    s_cselect_b32 s94, 0, s94
    s_bitcmp1_b32 0x2800, s35
    s_cselect_b32 s94, 0, s94
    s_cmp_eq_u32 s94, 0
    s_cbranch_scc1 L_nof
    s_lshl_b32 s57, s4, 13
    s_add_u32 s47, s57, 33792
    s_mov_b32 s90, 0x1c0000
    s_mov_b32 s91, 0x20000
    s_and_b32 s56, s95, 3
    s_lshl_b32 s57, s56, 2
    s_add_u32 s57, s57, s4
    s_mul_i32 s92, s57, 0x1c000
    s_lshr_b32 s57, s95, 3
    s_lshl_b32 s57, s57, 8
    s_add_u32 s92, s92, s57
    s_and_b32 s57, s95, 0xfc
    s_add_u32 s57, s57, s4
    s_lshl_b32 s57, s57, 15
    s_lshl_b32 s56, s56, 8
    s_add_u32 s57, s57, s56
    s_bitcmp0_b32 s95, 2
    s_cselect_b32 s88, s20, s22
    s_cselect_b32 s89, s21, s23
    s_movk_i32 s93, 0xe00
    s_cmp_eq_u32 s94, 2
    s_cselect_b32 s92, s57, s92
    s_cselect_b32 s93, 0x400, s93
    s_cselect_b32 s88, s24, s88
    s_cselect_b32 s89, s25, s89
    s_lshl_b32 s57, s93, 3
    v_lshlrev_b32 v16, 4, v3
    v_mad_u32_u24 v18, v2, s57, v16
    s_mov_b32 m0, s47
    s_add_u32 s47, s47, 0x400
    s_waitcnt vmcnt(6)
    buffer_load_dwordx4 v18, s[88:91], s92 offen nt lds
    s_add_u32 s92, s92, s93
    s_mov_b32 m0, s47
    s_add_u32 s47, s47, 0x400
    buffer_load_dwordx4 v18, s[88:91], s92 offen nt lds
    s_add_u32 s92, s92, s93
    s_mov_b32 m0, s47
    s_add_u32 s47, s47, 0x400
    s_waitcnt vmcnt(6)
    buffer_load_dwordx4 v18, s[88:91], s92 offen nt lds
    s_add_u32 s92, s92, s93
    s_mov_b32 m0, s47
    s_add_u32 s47, s47, 0x400
    buffer_load_dwordx4 v18, s[88:91], s92 offen nt lds
    s_add_u32 s92, s92, s93
    s_mov_b32 m0, s47
    s_add_u32 s47, s47, 0x400
    s_waitcnt vmcnt(6)
    buffer_load_dwordx4 v18, s[88:91], s92 offen nt lds
    s_add_u32 s92, s92, s93
    s_mov_b32 m0, s47
    s_add_u32 s47, s47, 0x400
    buffer_load_dwordx4 v18, s[88:91], s92 offen nt lds
    s_add_u32 s92, s92, s93
    s_mov_b32 m0, s47
    s_add_u32 s47, s47, 0x400
    s_waitcnt vmcnt(6)
    buffer_load_dwordx4 v18, s[88:91], s92 offen nt lds
    s_add_u32 s92, s92, s93
    s_mov_b32 m0, s47
    s_add_u32 s47, s47, 0x400
    buffer_load_dwordx4 v18, s[88:91], s92 offen nt lds
    s_add_u32 s92, s92, s93
L_nof:
    s_cmp_eq_u32 s94, 0
    s_cselect_b64 vcc, 0, -1
    s_waitcnt vmcnt(6)
    s_cbranch_vccnz L_pt1
    s_waitcnt vmcnt(4)
L_pt1:
    buffer_load_dwordx4 v[144:147], v14, s[36:39], s43 offen offset:0 nt
    buffer_load_dwordx4 v[148:151], v14, s[36:39], s43 offen offset:1024 nt
    s_xor_b32 s43, s42, 0x26000
    s_waitcnt vmcnt(6)
    s_cbranch_vccnz L_pt2
    s_waitcnt vmcnt(4)
L_pt2:
    buffer_load_dwordx4 v[152:155], v14, s[36:39], s43 offen offset:0 nt
    buffer_load_dwordx4 v[156:159], v14, s[36:39], s43 offen offset:1024 nt
    s_xor_b32 s43, s42, 0x40000
    s_waitcnt vmcnt(6)
    s_cbranch_vccnz L_pt3
    s_waitcnt vmcnt(4)
L_pt3:
    buffer_load_dwordx4 v[160:163], v14, s[36:39], s43 offen offset:0 nt
    buffer_load_dwordx4 v[164:167], v14, s[36:39], s43 offen offset:1024 nt
    s_xor_b32 s43, s42, 0x42000
    s_waitcnt vmcnt(6)
    s_cbranch_vccnz L_pt4
    s_waitcnt vmcnt(4)
L_pt4:
    buffer_load_dwordx4 v[168:171], v14, s[36:39], s43 offen offset:0 nt
    buffer_load_dwordx4 v[172:175], v14, s[36:39], s43 offen offset:1024 nt
    s_xor_b32 s43, s42, 0x44000
    s_waitcnt vmcnt(6)
    s_cbranch_vccnz L_pt5
    s_waitcnt vmcnt(4)
L_pt5:
    buffer_load_dwordx4 v[176:179], v14, s[36:39], s43 offen offset:0 nt
    buffer_load_dwordx4 v[180:183], v14, s[36:39], s43 offen offset:1024 nt
    s_xor_b32 s43, s42, 0x46000
    s_mov_b32 s49, 0x05040100
    s_mov_b32 s50, 0x07060302
    s_mov_b32 s51, 0xffff0000
    s_mov_b32 s53, 0x3fb8aa3b
    s_mov_b32 s41, 0x1e6000
    s_mov_b32 s44, 0x80000
    s_lshl_b32 s55, s3, 11
    v_mov_b32 v48, 0
    v_mov_b32 v49, 0
    v_mov_b32 v50, 0
    v_mov_b32 v51, 0
    v_mov_b32 v52, 0
    v_mov_b32 v53, 0
    v_mov_b32 v54, 0
    v_mov_b32 v55, 0
    v_mov_b32 v12, 0xff7fffff
    v_mov_b32 v17, 0
    v_mov_b32 v15, 1
    v_lshlrev_b32 v0, 2, v1
    v_lshrrev_b32 v16, 2, v1
    v_lshlrev_b32 v16, 4, v16
    v_lshl_add_u32 v16, v13, 4, v16
    s_lshl_b32 s56, s3, 12
    s_add_u32 s56, s56, 17408
    v_lshl_add_u32 v19, v2, 6, v13
    v_add_u32 v19, s56, v19
    s_mul_i32 s56, s3, 2176
    s_add_u32 s56, s56, 8192
    v_mul_u32_u24 v18, 34, v13
    v_lshl_add_u32 v18, v2, 7, v18
    v_and_b32 v20, 12, v1
    v_lshl_add_u32 v18, v20, 2, v18
    v_add_u32 v18, s56, v18
    s_mov_b32 s52, 0x3db504f3
    s_mov_b32 s48, 0
    s_mov_b32 s45, 0
    s_mov_b32 s57, 0
    s_mov_b32 s80, 0xf000f
    s_mov_b32 s81, 0xf000f
    s_mov_b32 s82, 0xf000f0
    s_mov_b32 s83, 0xf000f0
    s_mov_b32 s84, 0xf000f00
    s_mov_b32 s85, 0xf000f00
    s_mov_b32 s86, 0xf000f000
    s_mov_b32 s87, 0xf000f000
    s_waitcnt vmcnt(6)
    s_cbranch_vccnz L_pt6
    s_waitcnt vmcnt(4)
L_pt6:
    buffer_load_dwordx4 v[184:187], v14, s[36:39], s43 offen offset:0 nt
    buffer_load_dwordx4 v[188:191], v14, s[36:39], s43 offen offset:1024 nt
    s_xor_b32 s43, s42, 0x60000
    s_waitcnt vmcnt(6)
    s_cbranch_vccnz L_pt7
    s_waitcnt vmcnt(4)
L_pt7:
    buffer_load_dwordx4 v[192:195], v14, s[36:39], s43 offen offset:0 nt
    buffer_load_dwordx4 v[196:199], v14, s[36:39], s43 offen offset:1024 nt
    s_xor_b32 s43, s42, 0x62000
    s_waitcnt vmcnt(6)
    s_cbranch_vccnz L_pt8
    s_waitcnt vmcnt(4)
L_pt8:
    buffer_load_dwordx4 v[200:203], v14, s[36:39], s43 offen offset:0 nt
    buffer_load_dwordx4 v[204:207], v14, s[36:39], s43 offen offset:1024 nt
    s_xor_b32 s43, s42, 0x64000
    s_waitcnt vmcnt(6)
    s_cbranch_vccnz L_pt9
    s_waitcnt vmcnt(4)
L_pt9:
    buffer_load_dwordx4 v[208:211], v14, s[36:39], s43 offen offset:0 nt
    buffer_load_dwordx4 v[212:215], v14, s[36:39], s43 offen offset:1024 nt
    s_xor_b32 s43, s42, 0x66000
    s_waitcnt vmcnt(6)
    s_cbranch_vccnz L_pt10
    s_waitcnt vmcnt(4)
L_pt10:
    buffer_load_dwordx4 v[216:219], v14, s[36:39], s43 offen offset:0 nt
    buffer_load_dwordx4 v[220:223], v14, s[36:39], s43 offen offset:1024 nt
    s_xor_b32 s43, s42, 0x80000
    s_barrier
    ds_read_b128 v[4:7], v16 offset:512
    s_waitcnt lgkmcnt(0)
    s_mov_b64 vcc, 0
    s_mov_b32 s60, 0
    s_mov_b32 s61, 10
L_kloop:
    v_mfma_f32_16x16x32_bf16 v[32:35], v[96:99], v[4:7], 0
    v_mfma_f32_16x16x32_bf16 v[36:39], v[100:103], v[4:7], 0
    s_cbranch_vccnz L_ks11
    s_waitcnt vmcnt(6)
    s_cmp_eq_u32 s45, 0
    s_cbranch_scc1 L_th12
    s_waitcnt vmcnt(4)
    s_cmp_eq_u32 s45, 1
    s_cbranch_scc1 L_th12
    s_waitcnt vmcnt(2)
L_th12:
    buffer_load_dwordx4 v[96:99], v14, s[36:39], s43 offen offset:0 nt
    buffer_load_dwordx4 v[100:103], v14, s[36:39], s43 offen offset:1024 nt
    s_sub_u32 s44, s44, s41
    s_and_b32 s44, s44, s41
    s_xor_b32 s43, s44, s42
    s_add_u32 s57, s57, 4
    ds_add_u32 v0, v15 offset:0
L_ks11:
    ds_read2st64_b32 v[56:57], v17 offset0:0 offset1:1
    s_mov_b32 s58, s57
    s_nop 3
    v_add_f32_dpp v28, v35, v34 row_shl:4 row_mask:0xf bank_mask:0xf bound_ctrl:0
    v_add_f32_dpp v29, v39, v38 row_shl:4 row_mask:0xf bank_mask:0xf bound_ctrl:0
    v_add_f32_dpp v30, v33, v32 row_shl:4 row_mask:0xf bank_mask:0xf bound_ctrl:0
    v_add_f32_dpp v31, v37, v36 row_shl:4 row_mask:0xf bank_mask:0xf bound_ctrl:0
    v_mfma_f32_16x16x32_bf16 v[40:43], v[104:107], v[4:7], 0
    v_mfma_f32_16x16x32_bf16 v[44:47], v[108:111], v[4:7], 0
    s_cbranch_vccnz L_ks13
    s_waitcnt vmcnt(6)
    s_cmp_eq_u32 s45, 0
    s_cbranch_scc1 L_th14
    s_waitcnt vmcnt(4)
    s_cmp_eq_u32 s45, 1
    s_cbranch_scc1 L_th14
    s_waitcnt vmcnt(2)
L_th14:
    buffer_load_dwordx4 v[104:107], v14, s[36:39], s43 offen offset:0 nt
    buffer_load_dwordx4 v[108:111], v14, s[36:39], s43 offen offset:1024 nt
    s_sub_u32 s44, s44, s41
    s_and_b32 s44, s44, s41
    s_xor_b32 s43, s44, s42
    s_add_u32 s57, s57, 4
    ds_add_u32 v0, v15 offset:0
L_ks13:
    s_waitcnt lgkmcnt(0)
    v_sub_u32 v56, v57, v56
    s_nop 0
    v_readfirstlane_b32 s59, v56
    s_nop 0
    s_add_u32 s59, s59, s58
    s_cmp_gt_i32 s59, s60
    s_cselect_b32 s45, 1, 0
    s_cmp_gt_i32 s59, s61
    s_cselect_b32 s45, 2, s45
    v_add_f32_dpp v20, v28, v30 row_shl:8 row_mask:0xf bank_mask:0xf bound_ctrl:0
    v_add_f32_dpp v21, v29, v31 row_shl:8 row_mask:0xf bank_mask:0xf bound_ctrl:0
    v_cvt_pk_bf16_f32 v16, v20, v21
    v_lshlrev_b32 v20, 16, v16
    v_and_b32 v21, s51, v16
    v_mul_f32 v20, s52, v20
    v_mul_f32 v21, s52, v21
    v_cvt_pk_bf16_f32 v8, v20, v21
    v_max3_f32 v12, v12, v20, v21
    v_add_f32_dpp v28, v43, v42 row_shl:4 row_mask:0xf bank_mask:0xf bound_ctrl:0
    v_add_f32_dpp v29, v47, v46 row_shl:4 row_mask:0xf bank_mask:0xf bound_ctrl:0
    v_add_f32_dpp v30, v41, v40 row_shl:4 row_mask:0xf bank_mask:0xf bound_ctrl:0
    v_add_f32_dpp v31, v45, v44 row_shl:4 row_mask:0xf bank_mask:0xf bound_ctrl:0
    v_mfma_f32_16x16x32_bf16 v[32:35], v[112:115], v[4:7], 0
    v_mfma_f32_16x16x32_bf16 v[36:39], v[116:119], v[4:7], 0
    s_waitcnt vmcnt(6)
    s_cmp_eq_u32 s45, 0
    s_cbranch_scc1 L_th15
    s_waitcnt vmcnt(4)
    s_cmp_eq_u32 s45, 1
    s_cbranch_scc1 L_th15
    s_waitcnt vmcnt(2)
L_th15:
    buffer_load_dwordx4 v[112:115], v14, s[36:39], s43 offen offset:0 nt
    buffer_load_dwordx4 v[116:119], v14, s[36:39], s43 offen offset:1024 nt
    s_sub_u32 s44, s44, s41
    s_and_b32 s44, s44, s41
    s_xor_b32 s43, s44, s42
    s_add_u32 s57, s57, 4
    ds_add_u32 v0, v15 offset:0
    ds_read2st64_b32 v[56:57], v17 offset0:0 offset1:1
    s_mov_b32 s58, s57
    v_add_f32_dpp v20, v28, v30 row_shl:8 row_mask:0xf bank_mask:0xf bound_ctrl:0
    v_add_f32_dpp v21, v29, v31 row_shl:8 row_mask:0xf bank_mask:0xf bound_ctrl:0
    v_cvt_pk_bf16_f32 v16, v20, v21
    v_lshlrev_b32 v20, 16, v16
    v_and_b32 v21, s51, v16
    v_mul_f32 v20, s52, v20
    v_mul_f32 v21, s52, v21
    v_cvt_pk_bf16_f32 v9, v20, v21
    v_max3_f32 v12, v12, v20, v21
    v_add_f32_dpp v28, v35, v34 row_shl:4 row_mask:0xf bank_mask:0xf bound_ctrl:0
    v_add_f32_dpp v29, v39, v38 row_shl:4 row_mask:0xf bank_mask:0xf bound_ctrl:0
    v_add_f32_dpp v30, v33, v32 row_shl:4 row_mask:0xf bank_mask:0xf bound_ctrl:0
    v_add_f32_dpp v31, v37, v36 row_shl:4 row_mask:0xf bank_mask:0xf bound_ctrl:0
    v_mfma_f32_16x16x32_bf16 v[40:43], v[120:123], v[4:7], 0
    v_mfma_f32_16x16x32_bf16 v[44:47], v[124:127], v[4:7], 0
    s_cbranch_vccnz L_ks16
    s_waitcnt vmcnt(6)
    s_cmp_eq_u32 s45, 0
    s_cbranch_scc1 L_th17
    s_waitcnt vmcnt(4)
    s_cmp_eq_u32 s45, 1
    s_cbranch_scc1 L_th17
    s_waitcnt vmcnt(2)
L_th17:
    buffer_load_dwordx4 v[120:123], v14, s[36:39], s43 offen offset:0 nt
    buffer_load_dwordx4 v[124:127], v14, s[36:39], s43 offen offset:1024 nt
    s_sub_u32 s44, s44, s41
    s_and_b32 s44, s44, s41
    s_xor_b32 s43, s44, s42
    s_add_u32 s57, s57, 4
    ds_add_u32 v0, v15 offset:0
L_ks16:
    s_waitcnt lgkmcnt(0)
    v_sub_u32 v56, v57, v56
    s_nop 0
    v_readfirstlane_b32 s59, v56
    s_nop 0
    s_add_u32 s59, s59, s58
    s_cmp_gt_i32 s59, s60
    s_cselect_b32 s45, 1, 0
    s_cmp_gt_i32 s59, s61
    s_cselect_b32 s45, 2, s45
    v_add_f32_dpp v20, v28, v30 row_shl:8 row_mask:0xf bank_mask:0xf bound_ctrl:0
    v_add_f32_dpp v21, v29, v31 row_shl:8 row_mask:0xf bank_mask:0xf bound_ctrl:0
    v_cvt_pk_bf16_f32 v16, v20, v21
    v_lshlrev_b32 v20, 16, v16
    v_and_b32 v21, s51, v16
    v_mul_f32 v20, s52, v20
    v_mul_f32 v21, s52, v21
    v_cvt_pk_bf16_f32 v10, v20, v21
    v_max3_f32 v12, v12, v20, v21
    v_add_f32_dpp v28, v43, v42 row_shl:4 row_mask:0xf bank_mask:0xf bound_ctrl:0
    v_add_f32_dpp v29, v47, v46 row_shl:4 row_mask:0xf bank_mask:0xf bound_ctrl:0
    v_add_f32_dpp v30, v41, v40 row_shl:4 row_mask:0xf bank_mask:0xf bound_ctrl:0
    v_add_f32_dpp v31, v45, v44 row_shl:4 row_mask:0xf bank_mask:0xf bound_ctrl:0
    v_mfma_f32_16x16x32_bf16 v[32:35], v[128:131], v[4:7], 0
    v_mfma_f32_16x16x32_bf16 v[36:39], v[132:135], v[4:7], 0
    s_cbranch_vccnz L_ks18
    s_waitcnt vmcnt(6)
    s_cmp_eq_u32 s45, 0
    s_cbranch_scc1 L_th19
    s_waitcnt vmcnt(4)
    s_cmp_eq_u32 s45, 1
    s_cbranch_scc1 L_th19
    s_waitcnt vmcnt(2)
L_th19:
    buffer_load_dwordx4 v[128:131], v14, s[36:39], s43 offen offset:0 nt
    buffer_load_dwordx4 v[132:135], v14, s[36:39], s43 offen offset:1024 nt
    s_sub_u32 s44, s44, s41
    s_and_b32 s44, s44, s41
    s_xor_b32 s43, s44, s42
    s_add_u32 s57, s57, 4
    ds_add_u32 v0, v15 offset:0
L_ks18:
    ds_read2st64_b32 v[56:57], v17 offset0:0 offset1:1
    s_mov_b32 s58, s57
    v_add_f32_dpp v20, v28, v30 row_shl:8 row_mask:0xf bank_mask:0xf bound_ctrl:0
    v_add_f32_dpp v21, v29, v31 row_shl:8 row_mask:0xf bank_mask:0xf bound_ctrl:0
    v_cvt_pk_bf16_f32 v16, v20, v21
    v_lshlrev_b32 v20, 16, v16
    v_and_b32 v21, s51, v16
    v_mul_f32 v20, s52, v20
    v_mul_f32 v21, s52, v21
    v_cvt_pk_bf16_f32 v11, v20, v21
    v_max3_f32 v12, v12, v20, v21
    s_mov_b64 exec, s[80:81]
    ds_write_b128 v19, v[8:11] offset:0
    s_mov_b64 exec, -1
    v_add_f32_dpp v28, v35, v34 row_shl:4 row_mask:0xf bank_mask:0xf bound_ctrl:0
    v_add_f32_dpp v29, v39, v38 row_shl:4 row_mask:0xf bank_mask:0xf bound_ctrl:0
    v_add_f32_dpp v30, v33, v32 row_shl:4 row_mask:0xf bank_mask:0xf bound_ctrl:0
    v_add_f32_dpp v31, v37, v36 row_shl:4 row_mask:0xf bank_mask:0xf bound_ctrl:0
    v_mfma_f32_16x16x32_bf16 v[40:43], v[136:139], v[4:7], 0
    v_mfma_f32_16x16x32_bf16 v[44:47], v[140:143], v[4:7], 0
    s_waitcnt vmcnt(6)
    s_cmp_eq_u32 s45, 0
    s_cbranch_scc1 L_th20
    s_waitcnt vmcnt(4)
    s_cmp_eq_u32 s45, 1
    s_cbranch_scc1 L_th20
    s_waitcnt vmcnt(2)
L_th20:
    buffer_load_dwordx4 v[136:139], v14, s[36:39], s43 offen offset:0 nt
    buffer_load_dwordx4 v[140:143], v14, s[36:39], s43 offen offset:1024 nt
    s_sub_u32 s44, s44, s41
    s_and_b32 s44, s44, s41
    s_xor_b32 s43, s44, s42
    s_add_u32 s57, s57, 4
    ds_add_u32 v0, v15 offset:0
    s_waitcnt lgkmcnt(0)
    v_sub_u32 v56, v57, v56
    s_nop 0
    v_readfirstlane_b32 s59, v56
    s_nop 0
    s_add_u32 s59, s59, s58
    s_cmp_gt_i32 s59, s60
    s_cselect_b32 s45, 1, 0
    s_cmp_gt_i32 s59, s61
    s_cselect_b32 s45, 2, s45
    v_add_f32_dpp v20, v28, v30 row_shl:8 row_mask:0xf bank_mask:0xf bound_ctrl:0
    v_add_f32_dpp v21, v29, v31 row_shl:8 row_mask:0xf bank_mask:0xf bound_ctrl:0
    v_cvt_pk_bf16_f32 v16, v20, v21
    v_lshlrev_b32 v20, 16, v16
    v_and_b32 v21, s51, v16
    v_mul_f32 v20, s52, v20
    v_mul_f32 v21, s52, v21
    v_cvt_pk_bf16_f32 v8, v20, v21
    v_max3_f32 v12, v12, v20, v21
    v_add_f32_dpp v28, v43, v42 row_shl:4 row_mask:0xf bank_mask:0xf bound_ctrl:0
    v_add_f32_dpp v29, v47, v46 row_shl:4 row_mask:0xf bank_mask:0xf bound_ctrl:0
    v_add_f32_dpp v30, v41, v40 row_shl:4 row_mask:0xf bank_mask:0xf bound_ctrl:0
    v_add_f32_dpp v31, v45, v44 row_shl:4 row_mask:0xf bank_mask:0xf bound_ctrl:0
    v_mfma_f32_16x16x32_bf16 v[32:35], v[144:147], v[4:7], 0
    v_mfma_f32_16x16x32_bf16 v[36:39], v[148:151], v[4:7], 0
    s_cbranch_vccnz L_ks21
    s_waitcnt vmcnt(6)
    s_cmp_eq_u32 s45, 0
    s_cbranch_scc1 L_th22
    s_waitcnt vmcnt(4)
    s_cmp_eq_u32 s45, 1
    s_cbranch_scc1 L_th22
    s_waitcnt vmcnt(2)
L_th22:
    buffer_load_dwordx4 v[144:147], v14, s[36:39], s43 offen offset:0 nt
    buffer_load_dwordx4 v[148:151], v14, s[36:39], s43 offen offset:1024 nt
    s_sub_u32 s44, s44, s41
    s_and_b32 s44, s44, s41
    s_xor_b32 s43, s44, s42
    s_add_u32 s57, s57, 4
    ds_add_u32 v0, v15 offset:0
L_ks21:
    ds_read2st64_b32 v[56:57], v17 offset0:0 offset1:1
    s_mov_b32 s58, s57
    v_add_f32_dpp v20, v28, v30 row_shl:8 row_mask:0xf bank_mask:0xf bound_ctrl:0
    v_add_f32_dpp v21, v29, v31 row_shl:8 row_mask:0xf bank_mask:0xf bound_ctrl:0
    v_cvt_pk_bf16_f32 v16, v20, v21
    v_lshlrev_b32 v20, 16, v16
    v_and_b32 v21, s51, v16
    v_mul_f32 v20, s52, v20
    v_mul_f32 v21, s52, v21
    v_cvt_pk_bf16_f32 v9, v20, v21
    v_max3_f32 v12, v12, v20, v21
    v_add_f32_dpp v28, v35, v34 row_shl:4 row_mask:0xf bank_mask:0xf bound_ctrl:0
    v_add_f32_dpp v29, v39, v38 row_shl:4 row_mask:0xf bank_mask:0xf bound_ctrl:0
    v_add_f32_dpp v30, v33, v32 row_shl:4 row_mask:0xf bank_mask:0xf bound_ctrl:0
    v_add_f32_dpp v31, v37, v36 row_shl:4 row_mask:0xf bank_mask:0xf bound_ctrl:0
    v_mfma_f32_16x16x32_bf16 v[40:43], v[152:155], v[4:7], 0
    v_mfma_f32_16x16x32_bf16 v[44:47], v[156:159], v[4:7], 0
    s_cbranch_vccnz L_ks23
    s_waitcnt vmcnt(6)
    s_cmp_eq_u32 s45, 0
    s_cbranch_scc1 L_th24
    s_waitcnt vmcnt(4)
    s_cmp_eq_u32 s45, 1
    s_cbranch_scc1 L_th24
    s_waitcnt vmcnt(2)
L_th24:
    buffer_load_dwordx4 v[152:155], v14, s[36:39], s43 offen offset:0 nt
    buffer_load_dwordx4 v[156:159], v14, s[36:39], s43 offen offset:1024 nt
    s_sub_u32 s44, s44, s41
    s_and_b32 s44, s44, s41
    s_xor_b32 s43, s44, s42
    s_add_u32 s57, s57, 4
    ds_add_u32 v0, v15 offset:0
L_ks23:
    s_waitcnt lgkmcnt(0)
    v_sub_u32 v56, v57, v56
    s_nop 0
    v_readfirstlane_b32 s59, v56
    s_nop 0
    s_add_u32 s59, s59, s58
    s_cmp_gt_i32 s59, s60
    s_cselect_b32 s45, 1, 0
    s_cmp_gt_i32 s59, s61
    s_cselect_b32 s45, 2, s45
    v_add_f32_dpp v20, v28, v30 row_shl:8 row_mask:0xf bank_mask:0xf bound_ctrl:0
    v_add_f32_dpp v21, v29, v31 row_shl:8 row_mask:0xf bank_mask:0xf bound_ctrl:0
    v_cvt_pk_bf16_f32 v16, v20, v21
    v_lshlrev_b32 v20, 16, v16
    v_and_b32 v21, s51, v16
    v_mul_f32 v20, s52, v20
    v_mul_f32 v21, s52, v21
    v_cvt_pk_bf16_f32 v10, v20, v21
    v_max3_f32 v12, v12, v20, v21
    v_add_f32_dpp v28, v43, v42 row_shl:4 row_mask:0xf bank_mask:0xf bound_ctrl:0
    v_add_f32_dpp v29, v47, v46 row_shl:4 row_mask:0xf bank_mask:0xf bound_ctrl:0
    v_add_f32_dpp v30, v41, v40 row_shl:4 row_mask:0xf bank_mask:0xf bound_ctrl:0
    v_add_f32_dpp v31, v45, v44 row_shl:4 row_mask:0xf bank_mask:0xf bound_ctrl:0
    v_mfma_f32_16x16x32_bf16 v[32:35], v[160:163], v[4:7], 0
    v_mfma_f32_16x16x32_bf16 v[36:39], v[164:167], v[4:7], 0
    s_waitcnt vmcnt(6)
    s_cmp_eq_u32 s45, 0
    s_cbranch_scc1 L_th25
    s_waitcnt vmcnt(4)
    s_cmp_eq_u32 s45, 1
    s_cbranch_scc1 L_th25
    s_waitcnt vmcnt(2)
L_th25:
    buffer_load_dwordx4 v[160:163], v14, s[36:39], s43 offen offset:0 nt
    buffer_load_dwordx4 v[164:167], v14, s[36:39], s43 offen offset:1024 nt
    s_sub_u32 s44, s44, s41
    s_and_b32 s44, s44, s41
    s_xor_b32 s43, s44, s42
    s_add_u32 s57, s57, 4
    ds_add_u32 v0, v15 offset:0
    ds_read2st64_b32 v[56:57], v17 offset0:0 offset1:1
    s_mov_b32 s58, s57
    v_add_f32_dpp v20, v28, v30 row_shl:8 row_mask:0xf bank_mask:0xf bound_ctrl:0
    v_add_f32_dpp v21, v29, v31 row_shl:8 row_mask:0xf bank_mask:0xf bound_ctrl:0
    v_cvt_pk_bf16_f32 v16, v20, v21
    v_lshlrev_b32 v20, 16, v16
    v_and_b32 v21, s51, v16
    v_mul_f32 v20, s52, v20
    v_mul_f32 v21, s52, v21
    v_cvt_pk_bf16_f32 v11, v20, v21
    v_max3_f32 v12, v12, v20, v21
    s_mov_b64 exec, s[80:81]
    ds_write_b128 v19, v[8:11] offset:256
    s_mov_b64 exec, -1
    v_add_f32_dpp v28, v35, v34 row_shl:4 row_mask:0xf bank_mask:0xf bound_ctrl:0
    v_add_f32_dpp v29, v39, v38 row_shl:4 row_mask:0xf bank_mask:0xf bound_ctrl:0
    v_add_f32_dpp v30, v33, v32 row_shl:4 row_mask:0xf bank_mask:0xf bound_ctrl:0
    v_add_f32_dpp v31, v37, v36 row_shl:4 row_mask:0xf bank_mask:0xf bound_ctrl:0
    v_mfma_f32_16x16x32_bf16 v[40:43], v[168:171], v[4:7], 0
    v_mfma_f32_16x16x32_bf16 v[44:47], v[172:175], v[4:7], 0
    s_cbranch_vccnz L_ks26
    s_waitcnt vmcnt(6)
    s_cmp_eq_u32 s45, 0
    s_cbranch_scc1 L_th27
    s_waitcnt vmcnt(4)
    s_cmp_eq_u32 s45, 1
    s_cbranch_scc1 L_th27
    s_waitcnt vmcnt(2)
L_th27:
    buffer_load_dwordx4 v[168:171], v14, s[36:39], s43 offen offset:0 nt
    buffer_load_dwordx4 v[172:175], v14, s[36:39], s43 offen offset:1024 nt
    s_sub_u32 s44, s44, s41
    s_and_b32 s44, s44, s41
    s_xor_b32 s43, s44, s42
    s_add_u32 s57, s57, 4
    ds_add_u32 v0, v15 offset:0
L_ks26:
    s_waitcnt lgkmcnt(0)
    v_sub_u32 v56, v57, v56
    s_nop 0
    v_readfirstlane_b32 s59, v56
    s_nop 0
    s_add_u32 s59, s59, s58
    s_cmp_gt_i32 s59, s60
    s_cselect_b32 s45, 1, 0
    s_cmp_gt_i32 s59, s61
    s_cselect_b32 s45, 2, s45
    v_add_f32_dpp v20, v28, v30 row_shl:8 row_mask:0xf bank_mask:0xf bound_ctrl:0
    v_add_f32_dpp v21, v29, v31 row_shl:8 row_mask:0xf bank_mask:0xf bound_ctrl:0
    v_cvt_pk_bf16_f32 v16, v20, v21
    v_lshlrev_b32 v20, 16, v16
    v_and_b32 v21, s51, v16
    v_mul_f32 v20, s52, v20
    v_mul_f32 v21, s52, v21
    v_cvt_pk_bf16_f32 v8, v20, v21
    v_max3_f32 v12, v12, v20, v21
    v_add_f32_dpp v28, v43, v42 row_shl:4 row_mask:0xf bank_mask:0xf bound_ctrl:0
    v_add_f32_dpp v29, v47, v46 row_shl:4 row_mask:0xf bank_mask:0xf bound_ctrl:0
    v_add_f32_dpp v30, v41, v40 row_shl:4 row_mask:0xf bank_mask:0xf bound_ctrl:0
    v_add_f32_dpp v31, v45, v44 row_shl:4 row_mask:0xf bank_mask:0xf bound_ctrl:0
    v_mfma_f32_16x16x32_bf16 v[32:35], v[176:179], v[4:7], 0
    v_mfma_f32_16x16x32_bf16 v[36:39], v[180:183], v[4:7], 0
    s_cbranch_vccnz L_ks28
    s_waitcnt vmcnt(6)
    s_cmp_eq_u32 s45, 0
    s_cbranch_scc1 L_th29
    s_waitcnt vmcnt(4)
    s_cmp_eq_u32 s45, 1
    s_cbranch_scc1 L_th29
    s_waitcnt vmcnt(2)
L_th29:
    buffer_load_dwordx4 v[176:179], v14, s[36:39], s43 offen offset:0 nt
    buffer_load_dwordx4 v[180:183], v14, s[36:39], s43 offen offset:1024 nt
    s_sub_u32 s44, s44, s41
    s_and_b32 s44, s44, s41
    s_xor_b32 s43, s44, s42
    s_add_u32 s57, s57, 4
    ds_add_u32 v0, v15 offset:0
L_ks28:
    ds_read2st64_b32 v[56:57], v17 offset0:0 offset1:1
    s_mov_b32 s58, s57
    v_add_f32_dpp v20, v28, v30 row_shl:8 row_mask:0xf bank_mask:0xf bound_ctrl:0
    v_add_f32_dpp v21, v29, v31 row_shl:8 row_mask:0xf bank_mask:0xf bound_ctrl:0
    v_cvt_pk_bf16_f32 v16, v20, v21
    v_lshlrev_b32 v20, 16, v16
    v_and_b32 v21, s51, v16
    v_mul_f32 v20, s52, v20
    v_mul_f32 v21, s52, v21
    v_cvt_pk_bf16_f32 v9, v20, v21
    v_max3_f32 v12, v12, v20, v21
    v_add_f32_dpp v28, v35, v34 row_shl:4 row_mask:0xf bank_mask:0xf bound_ctrl:0
    v_add_f32_dpp v29, v39, v38 row_shl:4 row_mask:0xf bank_mask:0xf bound_ctrl:0
    v_add_f32_dpp v30, v33, v32 row_shl:4 row_mask:0xf bank_mask:0xf bound_ctrl:0
    v_add_f32_dpp v31, v37, v36 row_shl:4 row_mask:0xf bank_mask:0xf bound_ctrl:0
    v_mfma_f32_16x16x32_bf16 v[40:43], v[184:187], v[4:7], 0
    v_mfma_f32_16x16x32_bf16 v[44:47], v[188:191], v[4:7], 0
    s_waitcnt vmcnt(6)
    s_cmp_eq_u32 s45, 0
    s_cbranch_scc1 L_th30
    s_waitcnt vmcnt(4)
    s_cmp_eq_u32 s45, 1
    s_cbranch_scc1 L_th30
    s_waitcnt vmcnt(2)
L_th30:
    buffer_load_dwordx4 v[184:187], v14, s[36:39], s43 offen offset:0 nt
    buffer_load_dwordx4 v[188:191], v14, s[36:39], s43 offen offset:1024 nt
    s_sub_u32 s44, s44, s41
    s_and_b32 s44, s44, s41
    s_xor_b32 s43, s44, s42
    s_add_u32 s57, s57, 4
    ds_add_u32 v0, v15 offset:0
    s_waitcnt lgkmcnt(0)
    v_sub_u32 v56, v57, v56
    s_nop 0
    v_readfirstlane_b32 s59, v56
    s_nop 0
    s_add_u32 s59, s59, s58
    s_cmp_gt_i32 s59, s60
    s_cselect_b32 s45, 1, 0
    s_cmp_gt_i32 s59, s61
    s_cselect_b32 s45, 2, s45
    v_add_f32_dpp v20, v28, v30 row_shl:8 row_mask:0xf bank_mask:0xf bound_ctrl:0
    v_add_f32_dpp v21, v29, v31 row_shl:8 row_mask:0xf bank_mask:0xf bound_ctrl:0
    v_cvt_pk_bf16_f32 v16, v20, v21
    v_lshlrev_b32 v20, 16, v16
    v_and_b32 v21, s51, v16
    v_mul_f32 v20, s52, v20
    v_mul_f32 v21, s52, v21
    v_cvt_pk_bf16_f32 v10, v20, v21
    v_max3_f32 v12, v12, v20, v21
    v_add_f32_dpp v28, v43, v42 row_shl:4 row_mask:0xf bank_mask:0xf bound_ctrl:0
    v_add_f32_dpp v29, v47, v46 row_shl:4 row_mask:0xf bank_mask:0xf bound_ctrl:0
    v_add_f32_dpp v30, v41, v40 row_shl:4 row_mask:0xf bank_mask:0xf bound_ctrl:0
    v_add_f32_dpp v31, v45, v44 row_shl:4 row_mask:0xf bank_mask:0xf bound_ctrl:0
    v_mfma_f32_16x16x32_bf16 v[32:35], v[192:195], v[4:7], 0
    v_mfma_f32_16x16x32_bf16 v[36:39], v[196:199], v[4:7], 0
    s_cbranch_vccnz L_ks31
    s_waitcnt vmcnt(6)
    s_cmp_eq_u32 s45, 0
    s_cbranch_scc1 L_th32
    s_waitcnt vmcnt(4)
    s_cmp_eq_u32 s45, 1
    s_cbranch_scc1 L_th32
    s_waitcnt vmcnt(2)
L_th32:
    buffer_load_dwordx4 v[192:195], v14, s[36:39], s43 offen offset:0 nt
    buffer_load_dwordx4 v[196:199], v14, s[36:39], s43 offen offset:1024 nt
    s_sub_u32 s44, s44, s41
    s_and_b32 s44, s44, s41
    s_xor_b32 s43, s44, s42
    s_add_u32 s57, s57, 4
    ds_add_u32 v0, v15 offset:0
L_ks31:
    ds_read2st64_b32 v[56:57], v17 offset0:0 offset1:1
    s_mov_b32 s58, s57
    v_add_f32_dpp v20, v28, v30 row_shl:8 row_mask:0xf bank_mask:0xf bound_ctrl:0
    v_add_f32_dpp v21, v29, v31 row_shl:8 row_mask:0xf bank_mask:0xf bound_ctrl:0
    v_cvt_pk_bf16_f32 v16, v20, v21
    v_lshlrev_b32 v20, 16, v16
    v_and_b32 v21, s51, v16
    v_mul_f32 v20, s52, v20
    v_mul_f32 v21, s52, v21
    v_cvt_pk_bf16_f32 v11, v20, v21
    v_max3_f32 v12, v12, v20, v21
    s_mov_b64 exec, s[80:81]
    ds_write_b128 v19, v[8:11] offset:512
    s_mov_b64 exec, -1
    v_add_f32_dpp v28, v35, v34 row_shl:4 row_mask:0xf bank_mask:0xf bound_ctrl:0
    v_add_f32_dpp v29, v39, v38 row_shl:4 row_mask:0xf bank_mask:0xf bound_ctrl:0
    v_add_f32_dpp v30, v33, v32 row_shl:4 row_mask:0xf bank_mask:0xf bound_ctrl:0
    v_add_f32_dpp v31, v37, v36 row_shl:4 row_mask:0xf bank_mask:0xf bound_ctrl:0
    v_mfma_f32_16x16x32_bf16 v[40:43], v[200:203], v[4:7], 0
    v_mfma_f32_16x16x32_bf16 v[44:47], v[204:207], v[4:7], 0
    s_cbranch_vccnz L_ks33
    s_waitcnt vmcnt(6)
    s_cmp_eq_u32 s45, 0
    s_cbranch_scc1 L_th34
    s_waitcnt vmcnt(4)
    s_cmp_eq_u32 s45, 1
    s_cbranch_scc1 L_th34
    s_waitcnt vmcnt(2)
L_th34:
    buffer_load_dwordx4 v[200:203], v14, s[36:39], s43 offen offset:0 nt
    buffer_load_dwordx4 v[204:207], v14, s[36:39], s43 offen offset:1024 nt
    s_sub_u32 s44, s44, s41
    s_and_b32 s44, s44, s41
    s_xor_b32 s43, s44, s42
    s_add_u32 s57, s57, 4
    ds_add_u32 v0, v15 offset:0
L_ks33:
    s_waitcnt lgkmcnt(0)
    v_sub_u32 v56, v57, v56
    s_nop 0
    v_readfirstlane_b32 s59, v56
    s_nop 0
    s_add_u32 s59, s59, s58
    s_cmp_gt_i32 s59, s60
    s_cselect_b32 s45, 1, 0
    s_cmp_gt_i32 s59, s61
    s_cselect_b32 s45, 2, s45
    v_add_f32_dpp v20, v28, v30 row_shl:8 row_mask:0xf bank_mask:0xf bound_ctrl:0
    v_add_f32_dpp v21, v29, v31 row_shl:8 row_mask:0xf bank_mask:0xf bound_ctrl:0
    v_cvt_pk_bf16_f32 v16, v20, v21
    v_lshlrev_b32 v20, 16, v16
    v_and_b32 v21, s51, v16
    v_mul_f32 v20, s52, v20
    v_mul_f32 v21, s52, v21
    v_cvt_pk_bf16_f32 v8, v20, v21
    v_max3_f32 v12, v12, v20, v21
    v_add_f32_dpp v28, v43, v42 row_shl:4 row_mask:0xf bank_mask:0xf bound_ctrl:0
    v_add_f32_dpp v29, v47, v46 row_shl:4 row_mask:0xf bank_mask:0xf bound_ctrl:0
    v_add_f32_dpp v30, v41, v40 row_shl:4 row_mask:0xf bank_mask:0xf bound_ctrl:0
    v_add_f32_dpp v31, v45, v44 row_shl:4 row_mask:0xf bank_mask:0xf bound_ctrl:0
    v_mfma_f32_16x16x32_bf16 v[32:35], v[208:211], v[4:7], 0
    v_mfma_f32_16x16x32_bf16 v[36:39], v[212:215], v[4:7], 0
    s_waitcnt vmcnt(6)
    s_cmp_eq_u32 s45, 0
    s_cbranch_scc1 L_th35
    s_waitcnt vmcnt(4)
    s_cmp_eq_u32 s45, 1
    s_cbranch_scc1 L_th35
    s_waitcnt vmcnt(2)
L_th35:
    buffer_load_dwordx4 v[208:211], v14, s[36:39], s43 offen offset:0 nt
    buffer_load_dwordx4 v[212:215], v14, s[36:39], s43 offen offset:1024 nt
    s_sub_u32 s44, s44, s41
    s_and_b32 s44, s44, s41
    s_xor_b32 s43, s44, s42
    s_add_u32 s57, s57, 4
    ds_add_u32 v0, v15 offset:0
    ds_read2st64_b32 v[56:57], v17 offset0:0 offset1:1
    s_mov_b32 s58, s57
    v_add_f32_dpp v20, v28, v30 row_shl:8 row_mask:0xf bank_mask:0xf bound_ctrl:0
    v_add_f32_dpp v21, v29, v31 row_shl:8 row_mask:0xf bank_mask:0xf bound_ctrl:0
    v_cvt_pk_bf16_f32 v16, v20, v21
    v_lshlrev_b32 v20, 16, v16
    v_and_b32 v21, s51, v16
    v_mul_f32 v20, s52, v20
    v_mul_f32 v21, s52, v21
    v_cvt_pk_bf16_f32 v9, v20, v21
    v_max3_f32 v12, v12, v20, v21
    v_add_f32_dpp v28, v35, v34 row_shl:4 row_mask:0xf bank_mask:0xf bound_ctrl:0
    v_add_f32_dpp v29, v39, v38 row_shl:4 row_mask:0xf bank_mask:0xf bound_ctrl:0
    v_add_f32_dpp v30, v33, v32 row_shl:4 row_mask:0xf bank_mask:0xf bound_ctrl:0
    v_add_f32_dpp v31, v37, v36 row_shl:4 row_mask:0xf bank_mask:0xf bound_ctrl:0
    v_mfma_f32_16x16x32_bf16 v[40:43], v[216:219], v[4:7], 0
    v_mfma_f32_16x16x32_bf16 v[44:47], v[220:223], v[4:7], 0
    s_cbranch_vccnz L_ks36
    s_waitcnt vmcnt(6)
    s_cmp_eq_u32 s45, 0
    s_cbranch_scc1 L_th37
    s_waitcnt vmcnt(4)
    s_cmp_eq_u32 s45, 1
    s_cbranch_scc1 L_th37
    s_waitcnt vmcnt(2)
L_th37:
    buffer_load_dwordx4 v[216:219], v14, s[36:39], s43 offen offset:0 nt
    buffer_load_dwordx4 v[220:223], v14, s[36:39], s43 offen offset:1024 nt
    s_sub_u32 s44, s44, s41
    s_and_b32 s44, s44, s41
    s_xor_b32 s43, s44, s42
    s_add_u32 s57, s57, 4
    ds_add_u32 v0, v15 offset:0
L_ks36:
    s_waitcnt lgkmcnt(0)
    v_sub_u32 v56, v57, v56
    s_nop 0
    v_readfirstlane_b32 s59, v56
    s_nop 0
    s_add_u32 s59, s59, s58
    s_cmp_gt_i32 s59, s60
    s_cselect_b32 s45, 1, 0
    s_cmp_gt_i32 s59, s61
    s_cselect_b32 s45, 2, s45
    v_add_f32_dpp v20, v28, v30 row_shl:8 row_mask:0xf bank_mask:0xf bound_ctrl:0
    v_add_f32_dpp v21, v29, v31 row_shl:8 row_mask:0xf bank_mask:0xf bound_ctrl:0
    v_cvt_pk_bf16_f32 v16, v20, v21
    v_lshlrev_b32 v20, 16, v16
    v_and_b32 v21, s51, v16
    v_mul_f32 v20, s52, v20
    v_mul_f32 v21, s52, v21
    v_cvt_pk_bf16_f32 v10, v20, v21
    v_max3_f32 v12, v12, v20, v21
    v_add_f32_dpp v28, v43, v42 row_shl:4 row_mask:0xf bank_mask:0xf bound_ctrl:0
    v_add_f32_dpp v29, v47, v46 row_shl:4 row_mask:0xf bank_mask:0xf bound_ctrl:0
    v_add_f32_dpp v30, v41, v40 row_shl:4 row_mask:0xf bank_mask:0xf bound_ctrl:0
    v_add_f32_dpp v31, v45, v44 row_shl:4 row_mask:0xf bank_mask:0xf bound_ctrl:0
    s_nop 0
    v_add_f32_dpp v20, v28, v30 row_shl:8 row_mask:0xf bank_mask:0xf bound_ctrl:0
    v_add_f32_dpp v21, v29, v31 row_shl:8 row_mask:0xf bank_mask:0xf bound_ctrl:0
    v_cvt_pk_bf16_f32 v16, v20, v21
    v_lshlrev_b32 v20, 16, v16
    v_and_b32 v21, s51, v16
    v_mul_f32 v20, s52, v20
    v_mul_f32 v21, s52, v21
    v_cvt_pk_bf16_f32 v11, v20, v21
    v_max3_f32 v12, v12, v20, v21
    s_mov_b64 exec, s[80:81]
    ds_write_b128 v19, v[8:11] offset:768
    s_mov_b64 exec, -1
    s_add_u32 s48, s48, 1
    v_add_u32 v19, 1024, v19
    s_cmp_lt_u32 s48, 3
    s_cbranch_scc1 L_kloop
    s_cmp_eq_u32 s48, 3
    s_cbranch_scc0 L_kdone
    s_mov_b64 s[36:37], s[12:13]
    v_lshl_add_u32 v14, v1, 4, s55
    s_mov_b64 vcc, -1
    s_branch L_kloop
L_kdone:
    v_cvt_pk_bf16_f32 v12, v12, v12
    v_and_b32 v12, s51, v12
    v_add_u32 v19, -4096, v19
    v_mov_b32 v13, v12
    v_mov_b32 v32, 0
    v_mov_b32 v33, 0
    v_mov_b32 v34, 0
    v_mov_b32 v35, 0
    v_permlane32_swap_b32 v12, v13
    v_max_f32 v12, v12, v13
    v_mov_b32 v13, v12
    v_mov_b32 v36, 0
    v_mov_b32 v37, 0
    v_mov_b32 v38, 0
    v_mov_b32 v39, 0
    v_permlane16_swap_b32 v12, v13
    v_max_f32 v12, v12, v13
    v_mov_b32 v40, 0
    v_mov_b32 v41, 0
    v_mov_b32_dpp v12, v12 row_shr:4 row_mask:0xf bank_mask:0x2
    v_mov_b32 v42, 0
    v_mov_b32 v43, 0
    v_mov_b32_dpp v12, v12 row_shr:8 row_mask:0xf bank_mask:0x4
    v_mov_b32 v44, 0
    v_mov_b32 v45, 0
    v_mov_b32_dpp v12, v12 row_shr:12 row_mask:0xf bank_mask:0x8
    v_mov_b32 v46, 0
    v_mov_b32 v47, 0
    v_mul_f32 v12, s53, v12
    s_lshl_b32 s56, s3, 4
    v_add_u32 v13, s56, v0
    s_mov_b64 exec, 15
    ds_write_b32 v13, v12 offset:320
    s_waitcnt lgkmcnt(0)
    s_mov_b64 exec, 1
    ds_add_u32 v17, v15 offset:272
    s_mov_b64 exec, -1
    s_mov_b32 s48, 0
    s_mov_b64 vcc, 0
L_vloop:
    s_cmp_ge_u32 s48, 1
    s_cselect_b32 s60, -3, s60
    s_cselect_b32 s61, 4, s61
    ds_read_b128 v[28:31], v19 offset:0
    ds_read2st64_b32 v[56:57], v17 offset0:0 offset1:1
    s_mov_b32 s58, s57
    v_perm_b32 v64, v116, v112, s49
    v_perm_b32 v68, v116, v112, s50
    v_perm_b32 v72, v117, v113, s49
    v_perm_b32 v76, v117, v113, s50
    v_perm_b32 v80, v118, v114, s49
    v_perm_b32 v84, v118, v114, s50
    v_perm_b32 v88, v119, v115, s49
    v_perm_b32 v92, v119, v115, s50
    s_waitcnt lgkmcnt(0)
    v_sub_u32 v56, v57, v56
    s_nop 0
    v_readfirstlane_b32 s59, v56
    s_nop 0
    s_add_u32 s59, s59, s58
    s_cmp_gt_i32 s59, s60
    s_cselect_b32 s45, 1, 0
    s_cmp_gt_i32 s59, s61
    s_cselect_b32 s45, 2, s45
    s_waitcnt vmcnt(6)
    s_cmp_eq_u32 s45, 0
    s_cbranch_scc1 L_th38
    s_waitcnt vmcnt(4)
    s_cmp_eq_u32 s45, 1
    s_cbranch_scc1 L_th38
    s_waitcnt vmcnt(2)
L_th38:
    buffer_load_dwordx4 v[96:99], v14, s[36:39], s43 offen offset:0 nt
    buffer_load_dwordx4 v[100:103], v14, s[36:39], s43 offen offset:1024 nt
    s_sub_u32 s44, s44, s41
    s_and_b32 s44, s44, s41
    s_xor_b32 s43, s44, s42
    s_add_u32 s57, s57, 4
    ds_add_u32 v0, v15 offset:0
    ds_read2st64_b32 v[56:57], v17 offset0:0 offset1:1
    s_mov_b32 s58, s57
    v_perm_b32 v65, v140, v136, s49
    v_perm_b32 v69, v140, v136, s50
    v_perm_b32 v73, v141, v137, s49
    v_perm_b32 v77, v141, v137, s50
    v_perm_b32 v81, v142, v138, s49
    v_perm_b32 v85, v142, v138, s50
    v_perm_b32 v89, v143, v139, s49
    v_perm_b32 v93, v143, v139, s50
    s_waitcnt lgkmcnt(0)
    v_sub_u32 v56, v57, v56
    s_nop 0
    v_readfirstlane_b32 s59, v56
    s_nop 0
    s_add_u32 s59, s59, s58
    s_cmp_gt_i32 s59, s60
    s_cselect_b32 s45, 1, 0
    s_cmp_gt_i32 s59, s61
    s_cselect_b32 s45, 2, s45
    v_lshlrev_b32 v20, 16, v28
    v_and_b32 v21, s51, v28
    v_lshlrev_b32 v22, 16, v29
    v_and_b32 v23, s51, v29
    v_lshlrev_b32 v24, 16, v30
    v_and_b32 v25, s51, v30
    v_lshlrev_b32 v26, 16, v31
    v_and_b32 v27, s51, v31
    v_fma_f32 v20, v20, s53, -v12
    v_fma_f32 v21, v21, s53, -v12
    v_fma_f32 v22, v22, s53, -v12
    v_fma_f32 v23, v23, s53, -v12
    v_fma_f32 v24, v24, s53, -v12
    v_fma_f32 v25, v25, s53, -v12
    v_fma_f32 v26, v26, s53, -v12
    v_fma_f32 v27, v27, s53, -v12
    v_exp_f32 v20, v20
    v_exp_f32 v21, v21
    v_exp_f32 v22, v22
    v_exp_f32 v23, v23
    v_exp_f32 v24, v24
    v_exp_f32 v25, v25
    v_exp_f32 v26, v26
    v_exp_f32 v27, v27
    s_waitcnt vmcnt(6)
    s_cmp_eq_u32 s45, 0
    s_cbranch_scc1 L_th39
    s_waitcnt vmcnt(4)
    s_cmp_eq_u32 s45, 1
    s_cbranch_scc1 L_th39
    s_waitcnt vmcnt(2)
L_th39:
    buffer_load_dwordx4 v[104:107], v14, s[36:39], s43 offen offset:0 nt
    buffer_load_dwordx4 v[108:111], v14, s[36:39], s43 offen offset:1024 nt
    s_sub_u32 s44, s44, s41
    s_and_b32 s44, s44, s41
    s_xor_b32 s43, s44, s42
    s_add_u32 s57, s57, 4
    ds_add_u32 v0, v15 offset:0
    ds_read2st64_b32 v[56:57], v17 offset0:0 offset1:1
    s_mov_b32 s58, s57
    v_perm_b32 v66, v164, v160, s49
    v_perm_b32 v70, v164, v160, s50
    v_perm_b32 v74, v165, v161, s49
    v_perm_b32 v78, v165, v161, s50
    v_perm_b32 v82, v166, v162, s49
    v_perm_b32 v86, v166, v162, s50
    v_perm_b32 v90, v167, v163, s49
    v_perm_b32 v94, v167, v163, s50
    s_mov_b64 exec, s[80:81]
    v_cvt_pk_bf16_f32 v32, v20, v21
    v_cvt_pk_bf16_f32 v33, v22, v23
    v_cvt_pk_bf16_f32 v34, v24, v25
    v_cvt_pk_bf16_f32 v35, v26, v27
    s_mov_b64 exec, s[82:83]
    v_cvt_pk_bf16_f32 v36, v20, v21
    v_cvt_pk_bf16_f32 v37, v22, v23
    v_cvt_pk_bf16_f32 v38, v24, v25
    v_cvt_pk_bf16_f32 v39, v26, v27
    s_mov_b64 exec, s[84:85]
    v_cvt_pk_bf16_f32 v40, v20, v21
    v_cvt_pk_bf16_f32 v41, v22, v23
    v_cvt_pk_bf16_f32 v42, v24, v25
    v_cvt_pk_bf16_f32 v43, v26, v27
    s_mov_b64 exec, s[86:87]
    v_cvt_pk_bf16_f32 v44, v20, v21
    v_cvt_pk_bf16_f32 v45, v22, v23
    v_cvt_pk_bf16_f32 v46, v24, v25
    v_cvt_pk_bf16_f32 v47, v26, v27
    s_mov_b64 exec, -1
    s_waitcnt lgkmcnt(0)
    v_sub_u32 v56, v57, v56
    s_nop 0
    v_readfirstlane_b32 s59, v56
    s_nop 0
    s_add_u32 s59, s59, s58
    s_cmp_gt_i32 s59, s60
    s_cselect_b32 s45, 1, 0
    s_cmp_gt_i32 s59, s61
    s_cselect_b32 s45, 2, s45
    s_waitcnt vmcnt(6)
    s_cmp_eq_u32 s45, 0
    s_cbranch_scc1 L_th40
    s_waitcnt vmcnt(4)
    s_cmp_eq_u32 s45, 1
    s_cbranch_scc1 L_th40
    s_waitcnt vmcnt(2)
L_th40:
    buffer_load_dwordx4 v[120:123], v14, s[36:39], s43 offen offset:0 nt
    buffer_load_dwordx4 v[124:127], v14, s[36:39], s43 offen offset:1024 nt
    s_sub_u32 s44, s44, s41
    s_and_b32 s44, s44, s41
    s_xor_b32 s43, s44, s42
    s_add_u32 s57, s57, 4
    ds_add_u32 v0, v15 offset:0
    ds_read2st64_b32 v[56:57], v17 offset0:0 offset1:1
    s_mov_b32 s58, s57
    v_perm_b32 v67, v188, v184, s49
    v_perm_b32 v71, v188, v184, s50
    v_perm_b32 v75, v189, v185, s49
    v_perm_b32 v79, v189, v185, s50
    v_perm_b32 v83, v190, v186, s49
    v_perm_b32 v87, v190, v186, s50
    v_perm_b32 v91, v191, v187, s49
    v_perm_b32 v95, v191, v187, s50
    v_mfma_f32_16x16x32_bf16 v[48:51], v[64:67], v[32:35], v[48:51]
    v_mfma_f32_16x16x32_bf16 v[52:55], v[80:83], v[32:35], v[52:55]
    v_mfma_f32_16x16x32_bf16 v[48:51], v[68:71], v[36:39], v[48:51]
    v_mfma_f32_16x16x32_bf16 v[52:55], v[84:87], v[36:39], v[52:55]
    v_mfma_f32_16x16x32_bf16 v[48:51], v[72:75], v[40:43], v[48:51]
    v_mfma_f32_16x16x32_bf16 v[52:55], v[88:91], v[40:43], v[52:55]
    v_mfma_f32_16x16x32_bf16 v[48:51], v[76:79], v[44:47], v[48:51]
    v_mfma_f32_16x16x32_bf16 v[52:55], v[92:95], v[44:47], v[52:55]
    s_waitcnt lgkmcnt(0)
    v_sub_u32 v56, v57, v56
    s_nop 0
    v_readfirstlane_b32 s59, v56
    s_nop 0
    s_add_u32 s59, s59, s58
    s_cmp_gt_i32 s59, s60
    s_cselect_b32 s45, 1, 0
    s_cmp_gt_i32 s59, s61
    s_cselect_b32 s45, 2, s45
    s_cbranch_vccnz L_sk41
    s_waitcnt vmcnt(6)
    s_cmp_eq_u32 s45, 0
    s_cbranch_scc1 L_th42
    s_waitcnt vmcnt(4)
    s_cmp_eq_u32 s45, 1
    s_cbranch_scc1 L_th42
    s_waitcnt vmcnt(2)
L_th42:
    buffer_load_dwordx4 v[112:115], v14, s[36:39], s43 offen offset:0 nt
    buffer_load_dwordx4 v[116:119], v14, s[36:39], s43 offen offset:1024 nt
    s_sub_u32 s44, s44, s41
    s_and_b32 s44, s44, s41
    s_xor_b32 s43, s44, s42
    s_add_u32 s57, s57, 4
    ds_add_u32 v0, v15 offset:0
    s_branch L_jn43
L_sk41:
    v_mov_b32 v59, 0x1000
    ds_add_u32 v0, v59 offset:0
    s_waitcnt vmcnt(6)
    ds_add_u32 v0, v15 offset:0
L_jn43:
    ds_read_b128 v[28:31], v19 offset:256
    ds_read2st64_b32 v[56:57], v17 offset0:0 offset1:1
    s_mov_b32 s58, s57
    v_perm_b32 v64, v212, v208, s49
    v_perm_b32 v68, v212, v208, s50
    v_perm_b32 v72, v213, v209, s49
    v_perm_b32 v76, v213, v209, s50
    v_perm_b32 v80, v214, v210, s49
    v_perm_b32 v84, v214, v210, s50
    v_perm_b32 v88, v215, v211, s49
    v_perm_b32 v92, v215, v211, s50
    s_waitcnt lgkmcnt(0)
    v_sub_u32 v56, v57, v56
    s_nop 0
    v_readfirstlane_b32 s59, v56
    s_nop 0
    s_add_u32 s59, s59, s58
    s_cmp_gt_i32 s59, s60
    s_cselect_b32 s45, 1, 0
    s_cmp_gt_i32 s59, s61
    s_cselect_b32 s45, 2, s45
    s_cbranch_vccnz L_sk44
    s_waitcnt vmcnt(6)
    s_cmp_eq_u32 s45, 0
    s_cbranch_scc1 L_th45
    s_waitcnt vmcnt(4)
    s_cmp_eq_u32 s45, 1
    s_cbranch_scc1 L_th45
    s_waitcnt vmcnt(2)
L_th45:
    buffer_load_dwordx4 v[136:139], v14, s[36:39], s43 offen offset:0 nt
    buffer_load_dwordx4 v[140:143], v14, s[36:39], s43 offen offset:1024 nt
    s_sub_u32 s44, s44, s41
    s_and_b32 s44, s44, s41
    s_xor_b32 s43, s44, s42
    s_add_u32 s57, s57, 4
    ds_add_u32 v0, v15 offset:0
    s_branch L_jn46
L_sk44:
    s_waitcnt vmcnt(4)
    ds_add_u32 v0, v15 offset:0
L_jn46:
    ds_read2st64_b32 v[56:57], v17 offset0:0 offset1:1
    s_mov_b32 s58, s57
    v_perm_b32 v65, v100, v96, s49
    v_perm_b32 v69, v100, v96, s50
    v_perm_b32 v73, v101, v97, s49
    v_perm_b32 v77, v101, v97, s50
    v_perm_b32 v81, v102, v98, s49
    v_perm_b32 v85, v102, v98, s50
    v_perm_b32 v89, v103, v99, s49
    v_perm_b32 v93, v103, v99, s50
    s_waitcnt lgkmcnt(0)
    v_sub_u32 v56, v57, v56
    s_nop 0
    v_readfirstlane_b32 s59, v56
    s_nop 0
    s_add_u32 s59, s59, s58
    s_cmp_gt_i32 s59, s60
    s_cselect_b32 s45, 1, 0
    s_cmp_gt_i32 s59, s61
    s_cselect_b32 s45, 2, s45
    v_lshlrev_b32 v20, 16, v28
    v_and_b32 v21, s51, v28
    v_lshlrev_b32 v22, 16, v29
    v_and_b32 v23, s51, v29
    v_lshlrev_b32 v24, 16, v30
    v_and_b32 v25, s51, v30
    v_lshlrev_b32 v26, 16, v31
    v_and_b32 v27, s51, v31
    v_fma_f32 v20, v20, s53, -v12
    v_fma_f32 v21, v21, s53, -v12
    v_fma_f32 v22, v22, s53, -v12
    v_fma_f32 v23, v23, s53, -v12
    v_fma_f32 v24, v24, s53, -v12
    v_fma_f32 v25, v25, s53, -v12
    v_fma_f32 v26, v26, s53, -v12
    v_fma_f32 v27, v27, s53, -v12
    v_exp_f32 v20, v20
    v_exp_f32 v21, v21
    v_exp_f32 v22, v22
    v_exp_f32 v23, v23
    v_exp_f32 v24, v24
    v_exp_f32 v25, v25
    v_exp_f32 v26, v26
    v_exp_f32 v27, v27
    s_cbranch_vccnz L_sk47
    s_waitcnt vmcnt(6)
    s_cmp_eq_u32 s45, 0
    s_cbranch_scc1 L_th48
    s_waitcnt vmcnt(4)
    s_cmp_eq_u32 s45, 1
    s_cbranch_scc1 L_th48
    s_waitcnt vmcnt(2)
L_th48:
    buffer_load_dwordx4 v[160:163], v14, s[36:39], s43 offen offset:0 nt
    buffer_load_dwordx4 v[164:167], v14, s[36:39], s43 offen offset:1024 nt
    s_sub_u32 s44, s44, s41
    s_and_b32 s44, s44, s41
    s_xor_b32 s43, s44, s42
    s_add_u32 s57, s57, 4
    ds_add_u32 v0, v15 offset:0
    s_branch L_jn49
L_sk47:
    s_waitcnt vmcnt(2)
    ds_add_u32 v0, v15 offset:0
L_jn49:
    ds_read2st64_b32 v[56:57], v17 offset0:0 offset1:1
    s_mov_b32 s58, s57
    v_perm_b32 v66, v108, v104, s49
    v_perm_b32 v70, v108, v104, s50
    v_perm_b32 v74, v109, v105, s49
    v_perm_b32 v78, v109, v105, s50
    v_perm_b32 v82, v110, v106, s49
    v_perm_b32 v86, v110, v106, s50
    v_perm_b32 v90, v111, v107, s49
    v_perm_b32 v94, v111, v107, s50
    s_mov_b64 exec, s[80:81]
    v_cvt_pk_bf16_f32 v32, v20, v21
    v_cvt_pk_bf16_f32 v33, v22, v23
    v_cvt_pk_bf16_f32 v34, v24, v25
    v_cvt_pk_bf16_f32 v35, v26, v27
    s_mov_b64 exec, s[82:83]
    v_cvt_pk_bf16_f32 v36, v20, v21
    v_cvt_pk_bf16_f32 v37, v22, v23
    v_cvt_pk_bf16_f32 v38, v24, v25
    v_cvt_pk_bf16_f32 v39, v26, v27
    s_mov_b64 exec, s[84:85]
    v_cvt_pk_bf16_f32 v40, v20, v21
    v_cvt_pk_bf16_f32 v41, v22, v23
    v_cvt_pk_bf16_f32 v42, v24, v25
    v_cvt_pk_bf16_f32 v43, v26, v27
    s_mov_b64 exec, s[86:87]
    v_cvt_pk_bf16_f32 v44, v20, v21
    v_cvt_pk_bf16_f32 v45, v22, v23
    v_cvt_pk_bf16_f32 v46, v24, v25
    v_cvt_pk_bf16_f32 v47, v26, v27
    s_mov_b64 exec, -1
    s_waitcnt lgkmcnt(0)
    v_sub_u32 v56, v57, v56
    s_nop 0
    v_readfirstlane_b32 s59, v56
    s_nop 0
    s_add_u32 s59, s59, s58
    s_cmp_gt_i32 s59, s60
    s_cselect_b32 s45, 1, 0
    s_cmp_gt_i32 s59, s61
    s_cselect_b32 s45, 2, s45
    s_cbranch_vccnz L_sk50
    s_waitcnt vmcnt(6)
    s_cmp_eq_u32 s45, 0
    s_cbranch_scc1 L_th51
    s_waitcnt vmcnt(4)
    s_cmp_eq_u32 s45, 1
    s_cbranch_scc1 L_th51
    s_waitcnt vmcnt(2)
L_th51:
    buffer_load_dwordx4 v[184:187], v14, s[36:39], s43 offen offset:0 nt
    buffer_load_dwordx4 v[188:191], v14, s[36:39], s43 offen offset:1024 nt
    s_sub_u32 s44, s44, s41
    s_and_b32 s44, s44, s41
    s_xor_b32 s43, s44, s42
    s_add_u32 s57, s57, 4
    ds_add_u32 v0, v15 offset:0
    s_branch L_jn52
L_sk50:
    s_waitcnt vmcnt(0)
L_jn52:
    v_perm_b32 v67, v124, v120, s49
    v_perm_b32 v71, v124, v120, s50
    v_perm_b32 v75, v125, v121, s49
    v_perm_b32 v79, v125, v121, s50
    v_perm_b32 v83, v126, v122, s49
    v_perm_b32 v87, v126, v122, s50
    v_perm_b32 v91, v127, v123, s49
    v_perm_b32 v95, v127, v123, s50
    v_mfma_f32_16x16x32_bf16 v[48:51], v[64:67], v[32:35], v[48:51]
    v_mfma_f32_16x16x32_bf16 v[52:55], v[80:83], v[32:35], v[52:55]
    v_mfma_f32_16x16x32_bf16 v[48:51], v[68:71], v[36:39], v[48:51]
    v_mfma_f32_16x16x32_bf16 v[52:55], v[84:87], v[36:39], v[52:55]
    v_mfma_f32_16x16x32_bf16 v[48:51], v[72:75], v[40:43], v[48:51]
    v_mfma_f32_16x16x32_bf16 v[52:55], v[88:91], v[40:43], v[52:55]
    v_mfma_f32_16x16x32_bf16 v[48:51], v[76:79], v[44:47], v[48:51]
    v_mfma_f32_16x16x32_bf16 v[52:55], v[92:95], v[44:47], v[52:55]
    s_cbranch_vccnz L_vdone
    s_waitcnt vmcnt(6)
    s_cmp_eq_u32 s45, 0
    s_cbranch_scc1 L_th53
    s_waitcnt vmcnt(4)
    s_cmp_eq_u32 s45, 1
    s_cbranch_scc1 L_th53
    s_waitcnt vmcnt(2)
L_th53:
    buffer_load_dwordx4 v[208:211], v14, s[36:39], s43 offen offset:0 nt
    buffer_load_dwordx4 v[212:215], v14, s[36:39], s43 offen offset:1024 nt
    s_sub_u32 s44, s44, s41
    s_and_b32 s44, s44, s41
    s_xor_b32 s43, s44, s42
    s_add_u32 s57, s57, 4
    ds_add_u32 v0, v15 offset:0
    v_add_u32 v19, 512, v19
    s_add_u32 s48, s48, 1
    s_cmp_eq_u32 s48, 7
    s_cbranch_scc0 L_vloop
    s_mov_b64 vcc, -1
    s_branch L_vloop
L_vdone:
    s_nop 6
    ds_write_b128 v18, v[48:51]
    ds_write_b128 v18, v[52:55] offset:64
    s_waitcnt lgkmcnt(0)
    s_barrier
    s_endpgm
.p2align 8
L_aux:
    s_setprio 3
    v_and_b32 v1, 63, v0
    v_readfirstlane_b32 s3, v4
    s_and_b32 s32, s2, 7
    v_lshrrev_b32 v2, 4, v1
    s_and_b32 s4, s3, 3
    v_lshlrev_b32 v4, 5, v1
    v_and_b32 v24, 8, v1
    v_lshrrev_b32 v24, 1, v24
    v_add_u32 v24, v24, v2
    v_and_b32 v25, 7, v1
    v_lshlrev_b32 v25, 4, v25
    v_lshl_add_u32 v6, v24, 16, v25
    s_and_b32 s60, s2, 16
    s_lshr_b32 s57, s60, 2
    s_add_u32 s57, s57, s4
    s_and_b32 s54, s2, 8
    s_add_u32 s54, s54, s57
    s_lshl_b32 s54, s54, 7
    v_lshl_add_u32 v5, v24, 4, s54
    s_lshl_b32 s48, s57, 19
    s_lshr_b32 s61, s2, 5
    s_lshl3_add_u32 s55, s32, s61
    s_lshl_b32 s55, s55, 7
    s_add_u32 s48, s48, s55
    s_lshl_b32 s38, 1, 22
    v_mov_b32 v26, 0
    v_mov_b32 v27, 0
    v_lshlrev_b32 v28, 3, v1
    ds_write_b64 v28, v[26:27]
    s_waitcnt lgkmcnt(0)
    s_mov_b64 s[36:37], s[14:15]
    s_barrier
    global_load_dwordx4 v[8:11], v4, s[8:9]
    global_load_dwordx4 v[12:15], v4, s[8:9] offset:16
    global_load_dwordx4 v[16:19], v5, s[8:9]
    buffer_load_dwordx4 v[32:35], v6, s[36:39], s48 offen nt
    s_addk_i32 s48, 0x2000
    buffer_load_dwordx4 v[36:39], v6, s[36:39], s48 offen nt
    s_addk_i32 s48, 0x2000
    buffer_load_dwordx4 v[40:43], v6, s[36:39], s48 offen nt
    s_addk_i32 s48, 0x2000
    buffer_load_dwordx4 v[44:47], v6, s[36:39], s48 offen nt
    s_addk_i32 s48, 0x2000
    buffer_load_dwordx4 v[48:51], v6, s[36:39], s48 offen nt
    s_addk_i32 s48, 0x2000
    buffer_load_dwordx4 v[52:55], v6, s[36:39], s48 offen nt
    s_addk_i32 s48, 0x2000
    buffer_load_dwordx4 v[56:59], v6, s[36:39], s48 offen nt
    s_addk_i32 s48, 0x2000
    buffer_load_dwordx4 v[60:63], v6, s[36:39], s48 offen nt
    s_load_dword s47, s[30:31], 524288
    v_and_b32 v3, 15, v1
    s_and_b32 s35, s2, 15
    s_lshr_b32 s33, s35, 3
    s_lshr_b32 s34, s2, 4
    s_mov_b32 s49, 0x05040100
    s_mov_b32 s50, 0x07060302
    s_mov_b32 s51, 0xffff0000
    s_mov_b32 s53, 0x3fb8aa3b
    s_cmp_gt_u32 s35, 11
    s_subb_u32 s56, s35, 0
    s_cmp_gt_u32 s35, 13
    s_subb_u32 s56, s56, 0
    s_lshr_b32 s57, s34, 3
    s_sub_u32 s94, 2, s57
    s_add_u32 s57, s57, 2
    s_lshl_b32 s95, s56, s57
    s_and_b32 s57, s34, 7
    s_add_u32 s95, s95, s57
    s_lshr_b32 s5, s34, 2
    s_cmp_eq_u32 s5, 1
    s_cselect_b32 s94, 0, s94
    s_bitcmp1_b32 0x2800, s35
    s_cselect_b32 s94, 0, s94
    s_and_b32 s6, s34, 3
    s_lshl_b32 s7, s5, 2
    s_add_u32 s7, s7, s4
    s_lshr_b32 s98, s2, 3
    s_mul_i32 s98, s98, 4352
    s_add_u32 s98, s98, 2097152
    s_lshl_b32 s54, s32, 2
    s_add_u32 s54, s54, s4
    s_cmp_eq_u32 s54, 3
    s_cbranch_scc0 L_norst
    s_mov_b32 s99, 0
    s_atomic_swap s99, s[30:31], s98
L_norst:
    s_lshl_b32 s54, s4, 9
    s_add_u32 s54, s54, 2048
    v_lshl_add_u32 v29, v3, 5, s54
    s_add_u32 s96, s30, 917504
    s_addc_u32 s97, s31, 0
    s_getreg_b32 s44, hwreg(HW_REG_XCC_ID, 0, 4)
    s_lshl_b32 s54, s35, 13
    s_lshl_b32 s55, s60, 8
    s_add_u32 s55, s55, s54
    s_lshl_b32 s57, s61, 9
    s_add_u32 s55, s55, s57
    v_lshl_add_u32 v7, v1, 4, s55
    s_lshl_b32 s55, s4, 10
    s_add_u32 s55, s55, s54
    s_add_u32 s55, s55, 0x1000
    v_lshl_add_u32 v4, v1, 4, s55
    s_waitcnt vmcnt(9)
    v_lshlrev_b32 v224, 16, v8
    v_and_b32 v225, s51, v8
    v_lshlrev_b32 v226, 16, v9
    v_and_b32 v227, s51, v9
    v_lshlrev_b32 v228, 16, v10
    v_and_b32 v229, s51, v10
    v_lshlrev_b32 v230, 16, v11
    v_and_b32 v231, s51, v11
    v_lshlrev_b32 v232, 16, v12
    v_and_b32 v233, s51, v12
    v_lshlrev_b32 v234, 16, v13
    v_and_b32 v235, s51, v13
    v_lshlrev_b32 v236, 16, v14
    v_and_b32 v237, s51, v14
    v_lshlrev_b32 v238, 16, v15
    v_and_b32 v239, s51, v15
    v_pk_add_f32 v[8:9], v[224:225], v[226:227]
    v_pk_add_f32 v[10:11], v[228:229], v[230:231]
    v_pk_add_f32 v[12:13], v[232:233], v[234:235]
    v_pk_add_f32 v[14:15], v[236:237], v[238:239]
    v_pk_add_f32 v[8:9], v[8:9], v[10:11]
    v_pk_add_f32 v[12:13], v[12:13], v[14:15]
    v_pk_add_f32 v[8:9], v[8:9], v[12:13]
    v_add_f32 v24, v8, v9
    s_nop 1
    v_add_f32_dpp v24, v24, v24 row_ror:8 row_mask:0xf bank_mask:0xf
    s_nop 1
    v_add_f32_dpp v24, v24, v24 row_ror:4 row_mask:0xf bank_mask:0xf
    s_nop 1
    v_add_f32_dpp v24, v24, v24 row_ror:2 row_mask:0xf bank_mask:0xf
    s_nop 1
    v_add_f32_dpp v24, v24, v24 row_ror:1 row_mask:0xf bank_mask:0xf
    v_mov_b32 v25, v24
    s_nop 1
    v_permlane16_swap_b32 v24, v25
    v_add_f32 v24, v24, v25
    v_mul_f32 v24, 0x3b000000, v24
    v_sub_f32 v224, v224, v24
    v_sub_f32 v225, v225, v24
    v_sub_f32 v226, v226, v24
    v_sub_f32 v227, v227, v24
    v_sub_f32 v228, v228, v24
    v_sub_f32 v229, v229, v24
    v_sub_f32 v230, v230, v24
    v_sub_f32 v231, v231, v24
    v_sub_f32 v232, v232, v24
    v_sub_f32 v233, v233, v24
    v_sub_f32 v234, v234, v24
    v_sub_f32 v235, v235, v24
    v_sub_f32 v236, v236, v24
    v_sub_f32 v237, v237, v24
    v_sub_f32 v238, v238, v24
    v_sub_f32 v239, v239, v24
    v_mul_f32 v26, v224, v224
    v_mul_f32 v27, v225, v225
    v_fmac_f32 v26, v226, v226
    v_fmac_f32 v27, v227, v227
    v_fmac_f32 v26, v228, v228
    v_fmac_f32 v27, v229, v229
    v_fmac_f32 v26, v230, v230
    v_fmac_f32 v27, v231, v231
    v_fmac_f32 v26, v232, v232
    v_fmac_f32 v27, v233, v233
    v_fmac_f32 v26, v234, v234
    v_fmac_f32 v27, v235, v235
    v_fmac_f32 v26, v236, v236
    v_fmac_f32 v27, v237, v237
    v_fmac_f32 v26, v238, v238
    v_fmac_f32 v27, v239, v239
    v_add_f32 v26, v26, v27
    s_nop 1
    v_add_f32_dpp v26, v26, v26 row_ror:8 row_mask:0xf bank_mask:0xf
    s_nop 1
    v_add_f32_dpp v26, v26, v26 row_ror:4 row_mask:0xf bank_mask:0xf
    s_nop 1
    v_add_f32_dpp v26, v26, v26 row_ror:2 row_mask:0xf bank_mask:0xf
    s_nop 1
    v_add_f32_dpp v26, v26, v26 row_ror:1 row_mask:0xf bank_mask:0xf
    v_mov_b32 v25, v26
    s_nop 1
    v_permlane16_swap_b32 v26, v25
    v_add_f32 v26, v26, v25
    v_mul_f32 v26, 0x3b000000, v26
    v_cvt_pk_bf16_f32 v24, v24, v26
    v_and_b32 v26, s51, v24
    v_lshlrev_b32 v24, 16, v24
    v_add_f32 v26, 0x3727c5ac, v26
    v_cvt_pk_bf16_f32 v26, v26, v26
    v_and_b32 v26, s51, v26
    v_sqrt_f32 v26, v26
    s_nop 0
    v_cvt_pk_bf16_f32 v26, v26, v26
    v_and_b32 v26, s51, v26
    v_rcp_f32 v26, v26
    v_readlane_b32 s60, v24, 0
    v_readlane_b32 s62, v24, 32
    v_readlane_b32 s61, v26, 0
    v_readlane_b32 s63, v26, 32
    s_cmp_eq_u32 s33, 0
    s_cselect_b32 s54, s60, s62
    s_cselect_b32 s55, s61, s63
    v_mov_b32 v30, s54
    v_mov_b32 v31, s55
    s_waitcnt vmcnt(8)
    v_lshlrev_b32 v224, 16, v16
    v_and_b32 v225, s51, v16
    v_lshlrev_b32 v226, 16, v17
    v_and_b32 v227, s51, v17
    v_lshlrev_b32 v228, 16, v18
    v_and_b32 v229, s51, v18
    v_lshlrev_b32 v230, 16, v19
    v_and_b32 v231, s51, v19
    v_sub_f32 v224, v224, v30
    v_sub_f32 v225, v225, v30
    v_sub_f32 v226, v226, v30
    v_sub_f32 v227, v227, v30
    v_sub_f32 v228, v228, v30
    v_sub_f32 v229, v229, v30
    v_sub_f32 v230, v230, v30
    v_sub_f32 v231, v231, v30
    v_cvt_pk_bf16_f32 v20, v224, v225
    v_cvt_pk_bf16_f32 v21, v226, v227
    v_cvt_pk_bf16_f32 v22, v228, v229
    v_cvt_pk_bf16_f32 v23, v230, v231
    v_lshlrev_b32 v224, 16, v20
    v_and_b32 v225, s51, v20
    v_lshlrev_b32 v226, 16, v21
    v_and_b32 v227, s51, v21
    v_lshlrev_b32 v228, 16, v22
    v_and_b32 v229, s51, v22
    v_lshlrev_b32 v230, 16, v23
    v_and_b32 v231, s51, v23
    v_mul_f32 v224, v224, v31
    v_mul_f32 v225, v225, v31
    v_mul_f32 v226, v226, v31
    v_mul_f32 v227, v227, v31
    v_mul_f32 v228, v228, v31
    v_mul_f32 v229, v229, v31
    v_mul_f32 v230, v230, v31
    v_mul_f32 v231, v231, v31
    v_cvt_pk_bf16_f32 v20, v224, v225
    v_cvt_pk_bf16_f32 v21, v226, v227
    v_cvt_pk_bf16_f32 v22, v228, v229
    v_cvt_pk_bf16_f32 v23, v230, v231
    s_waitcnt vmcnt(0)
    v_perm_b32 v96, v36, v32, s49
    v_perm_b32 v97, v44, v40, s49
    v_perm_b32 v98, v52, v48, s49
    v_perm_b32 v99, v60, v56, s49
    v_perm_b32 v100, v36, v32, s50
    v_perm_b32 v101, v44, v40, s50
    v_perm_b32 v102, v52, v48, s50
    v_perm_b32 v103, v60, v56, s50
    v_perm_b32 v104, v37, v33, s49
    v_perm_b32 v105, v45, v41, s49
    v_perm_b32 v106, v53, v49, s49
    v_perm_b32 v107, v61, v57, s49
    v_perm_b32 v108, v37, v33, s50
    v_perm_b32 v109, v45, v41, s50
    v_perm_b32 v110, v53, v49, s50
    v_perm_b32 v111, v61, v57, s50
    v_perm_b32 v112, v38, v34, s49
    v_perm_b32 v113, v46, v42, s49
    v_perm_b32 v114, v54, v50, s49
    v_perm_b32 v115, v62, v58, s49
    v_perm_b32 v116, v38, v34, s50
    v_perm_b32 v117, v46, v42, s50
    v_perm_b32 v118, v54, v50, s50
    v_perm_b32 v119, v62, v58, s50
    v_perm_b32 v120, v39, v35, s49
    v_perm_b32 v121, v47, v43, s49
    v_perm_b32 v122, v55, v51, s49
    v_perm_b32 v123, v63, v59, s49
    v_perm_b32 v124, v39, v35, s50
    v_perm_b32 v125, v47, v43, s50
    v_perm_b32 v126, v55, v51, s50
    v_perm_b32 v127, v63, v59, s50
    v_mfma_f32_16x16x32_bf16 v[128:131], v[20:23], v[96:99], 0
    v_mfma_f32_16x16x32_bf16 v[132:135], v[20:23], v[100:103], 0
    v_mfma_f32_16x16x32_bf16 v[136:139], v[20:23], v[104:107], 0
    v_mfma_f32_16x16x32_bf16 v[140:143], v[20:23], v[108:111], 0
    v_mfma_f32_16x16x32_bf16 v[144:147], v[20:23], v[112:115], 0
    v_mfma_f32_16x16x32_bf16 v[148:151], v[20:23], v[116:119], 0
    v_mfma_f32_16x16x32_bf16 v[152:155], v[20:23], v[120:123], 0
    v_mfma_f32_16x16x32_bf16 v[156:159], v[20:23], v[124:127], 0
    v_mov_b32 v24, 0
    v_mov_b32 v25, 1
    s_waitcnt lgkmcnt(0)
    s_add_u32 s46, s47, 0x9e3779b9
    s_mov_b32 exec_lo, 0xff
    s_mov_b32 exec_hi, 0xff00
    ds_write2_b32 v29, v128, v132 offset0:0 offset1:1
    ds_write2_b32 v29, v136, v140 offset0:2 offset1:3
    ds_write2_b32 v29, v144, v148 offset0:4 offset1:5
    ds_write2_b32 v29, v152, v156 offset0:6 offset1:7
    s_mov_b64 exec, 1
    s_waitcnt lgkmcnt(0)
    ds_add_rtn_u32 v27, v24, v25 offset:264
    s_waitcnt lgkmcnt(0)
    v_readfirstlane_b32 s54, v27
    s_mov_b64 exec, -1
    s_cmp_eq_u32 s54, 3
    s_cbranch_scc0 L_qwait
    ds_read_b64 v[8:9], v28 offset:2048
    ds_read_b64 v[10:11], v28 offset:2560
    ds_read_b64 v[12:13], v28 offset:3072
    ds_read_b64 v[14:15], v28 offset:3584
    s_waitcnt lgkmcnt(0)
    v_pk_add_f32 v[8:9], v[8:9], v[10:11]
    v_pk_add_f32 v[12:13], v[12:13], v[14:15]
    v_mov_b32 v10, s46
    v_pk_add_f32 v[8:9], v[8:9], v[12:13]
    v_mov_b32 v12, v8
    v_mov_b32 v13, v9
    v_mov_b32 v11, s44
    v_permlane32_swap_b32 v8, v12
    v_permlane32_swap_b32 v9, v13
    v_pk_add_f32 v[8:9], v[8:9], v[12:13]
    s_mov_b32 exec_hi, 0
    global_store_dwordx4 v7, v[8:11], s[96:97]
    global_store_dwordx4 v7, v[8:11], s[30:31] sc1
    s_mov_b32 exec_hi, -1
L_qwait:
    s_mov_b32 s58, 1048576
    s_mov_b64 s[80:81], -1
    s_mov_b64 s[82:83], -1
L_pq:
    s_and_b32 s54, s58, 3
    s_cmp_eq_u32 s54, 1
    s_cbranch_scc1 L_pqx
    s_wqm_b64 exec, s[80:81]
    s_cbranch_execz L_pqf0
    global_load_dwordx4 v[32:35], v4, s[96:97] offset:-4096 nt
L_pqf0:
    s_wqm_b64 exec, s[82:83]
    s_cbranch_execz L_pqf1
    global_load_dwordx4 v[36:39], v4, s[96:97] offset:0 nt
L_pqf1:
    s_branch L_pqy
L_pqx:
    s_wqm_b64 exec, s[80:81]
    s_cbranch_execz L_pqs0
    global_load_dwordx4 v[32:35], v4, s[30:31] offset:-4096 sc1
L_pqs0:
    s_wqm_b64 exec, s[82:83]
    s_cbranch_execz L_pqs1
    global_load_dwordx4 v[36:39], v4, s[30:31] offset:0 sc1
L_pqs1:
L_pqy:
    s_waitcnt vmcnt(0)
    s_wqm_b64 exec, s[80:81]
    v_cmp_ne_u32 s[80:81], s46, v34
    s_wqm_b64 exec, s[82:83]
    v_cmp_ne_u32 s[82:83], s46, v38
    s_mov_b64 exec, -1
    s_or_b64 vcc, s[80:81], s[80:81]
    s_or_b64 vcc, vcc, s[82:83]
    s_cbranch_scc0 L_pqd
    s_sub_u32 s58, s58, 1
    s_cbranch_scc0 L_pq
L_pqd:
    s_lshl_b32 s54, s4, 8
    v_lshl_add_u32 v4, v1, 2, s54
    v_pk_add_f32 v[32:33], v[32:33], v[36:37]
    v_cvt_pk_bf16_f32 v32, v32, v33
    ds_write_b32 v4, v32 offset:512
    v_xor_b32 v5, s44, v35
    v_bitop3_b32 v5, v5, v39, s44 bitop3:0xf6
    v_cmp_ne_u32 vcc, 0, v5
    s_nop 0
    s_mov_b64 exec, vcc
    s_cbranch_execz L_near
    ds_write_b32 v24, v5 offset:260
L_near:
    s_mov_b64 exec, -1
    s_waitcnt lgkmcnt(0)
    s_barrier
    s_setprio 0
    ds_read_b32 v5, v24 offset:260
    s_mov_b32 s59, 0
    s_waitcnt lgkmcnt(0)
    v_readfirstlane_b32 s45, v5
    s_cmp_eq_u32 s94, 0
    s_cbranch_scc1 L_role
    s_lshl_b32 s54, s4, 13
    s_add_u32 s54, s54, 33792
    v_lshl_add_u32 v5, v1, 4, s54
    v_and_b32 v4, 1, v1
    ds_read_b128 v[192:195], v5 offset:0
    ds_read_b128 v[196:199], v5 offset:1024
    ds_read_b128 v[200:203], v5 offset:2048
    ds_read_b128 v[204:207], v5 offset:3072
    ds_read_b128 v[208:211], v5 offset:4096
    ds_read_b128 v[212:215], v5 offset:5120
    ds_read_b128 v[216:219], v5 offset:6144
    ds_read_b128 v[220:223], v5 offset:7168
    s_cmp_eq_u32 s94, 2
    s_cbranch_scc1 L_down
    v_and_b32 v26, 1, v1
    s_and_b32 s54, s95, 3
    s_lshl_b32 s54, s54, 2
    s_add_u32 s54, s54, s4
    s_lshl_b32 s54, s54, 6
    v_lshl_add_u32 v5, v26, 10, s54
    v_lshl_add_u32 v5, v2, 4, v5
    global_load_dwordx4 v[16:19], v5, s[8:9]
    v_cmp_eq_u32 vcc, 1, v26
    v_mov_b32 v30, s60
    v_mov_b32 v31, s62
    v_mov_b32 v5, s61
    v_mov_b32 v6, s63
    v_cndmask_b32 v30, v30, v31, vcc
    v_cndmask_b32 v31, v5, v6, vcc
    s_waitcnt vmcnt(0)
    v_lshlrev_b32 v224, 16, v16
    v_and_b32 v225, s51, v16
    v_lshlrev_b32 v226, 16, v17
    v_and_b32 v227, s51, v17
    v_lshlrev_b32 v228, 16, v18
    v_and_b32 v229, s51, v18
    v_lshlrev_b32 v230, 16, v19
    v_and_b32 v231, s51, v19
    v_sub_f32 v224, v224, v30
    v_sub_f32 v225, v225, v30
    v_sub_f32 v226, v226, v30
    v_sub_f32 v227, v227, v30
    v_sub_f32 v228, v228, v30
    v_sub_f32 v229, v229, v30
    v_sub_f32 v230, v230, v30
    v_sub_f32 v231, v231, v30
    v_cvt_pk_bf16_f32 v20, v224, v225
    v_cvt_pk_bf16_f32 v21, v226, v227
    v_cvt_pk_bf16_f32 v22, v228, v229
    v_cvt_pk_bf16_f32 v23, v230, v231
    v_lshlrev_b32 v224, 16, v20
    v_and_b32 v225, s51, v20
    v_lshlrev_b32 v226, 16, v21
    v_and_b32 v227, s51, v21
    v_lshlrev_b32 v228, 16, v22
    v_and_b32 v229, s51, v22
    v_lshlrev_b32 v230, 16, v23
    v_and_b32 v231, s51, v23
    v_mul_f32 v224, v224, v31
    v_mul_f32 v225, v225, v31
    v_mul_f32 v226, v226, v31
    v_mul_f32 v227, v227, v31
    v_mul_f32 v228, v228, v31
    v_mul_f32 v229, v229, v31
    v_mul_f32 v230, v230, v31
    v_mul_f32 v231, v231, v31
    v_cvt_pk_bf16_f32 v20, v224, v225
    v_cvt_pk_bf16_f32 v21, v226, v227
    v_cvt_pk_bf16_f32 v22, v228, v229
    v_cvt_pk_bf16_f32 v23, v230, v231
    s_branch L_ftile
L_down:
    s_mov_b32 s58, 1048576
L_wd:
    ds_read_b32 v27, v24 offset:0
    s_waitcnt lgkmcnt(0)
    v_cmp_gt_u32 vcc, 12, v27
    s_cbranch_vccz L_wdd
    s_sleep 8
    s_sub_u32 s58, s58, 1
    s_cbranch_scc0 L_wd
L_wdd:
    s_lshr_b32 s54, s95, 2
    s_lshl_b32 s54, s54, 14
    s_lshl_b32 s55, s4, 9
    s_add_u32 s54, s54, s55
    s_add_u32 s54, s54, 593920
    v_lshrrev_b32 v5, 5, v1
    v_lshlrev_b32 v5, 13, v5
    v_and_b32 v6, 31, v1
    v_lshl_add_u32 v5, v6, 4, v5
    v_add_u32 v5, s54, v5
    s_mov_b32 s58, 1048576
L_pg:
    global_load_dwordx4 v[128:131], v5, s[30:31] offset:-4096 sc1
    global_load_dwordx4 v[132:135], v5, s[30:31] offset:-2048 sc1
    global_load_dwordx4 v[136:139], v5, s[30:31] offset:0 sc1
    global_load_dwordx4 v[140:143], v5, s[30:31] offset:2048 sc1
    s_waitcnt vmcnt(0)
    v_xor_b32 v12, s46, v130
    v_bitop3_b32 v12, v12, v134, s46 bitop3:0xf6
    v_bitop3_b32 v12, v12, v138, s46 bitop3:0xf6
    v_bitop3_b32 v12, v12, v142, s46 bitop3:0xf6
    v_cmp_ne_u32 vcc, 0, v12
    s_cbranch_vccz L_pgd
    s_sleep 12
    s_sub_u32 s58, s58, 1
    s_cbranch_scc0 L_pg
L_pgd:
    v_pk_add_f32 v[128:129], v[128:129], v[132:133]
    v_pk_add_f32 v[136:137], v[136:137], v[140:141]
    v_pk_add_f32 v[128:129], v[128:129], v[136:137]
    s_nop 1
    v_permlane32_swap_b32 v128, v129
    v_cvt_pk_bf16_f32 v26, v128, v129
    v_lshlrev_b32 v27, 16, v26
    v_and_b32 v26, s51, v26
    v_max_f32 v27, 0, v27
    v_mul_f32 v26, v26, v27
    v_cvt_pk_bf16_f32 v26, v26, v26
    s_lshl_b32 s54, s4, 7
    s_add_u32 s54, s54, 1536
    v_lshl_add_u32 v5, v1, 1, s54
    v_lshl_add_u32 v6, v4, 6, s54
    v_lshl_add_u32 v6, v2, 4, v6
    ds_write_b16 v5, v26
    s_waitcnt lgkmcnt(0)
    ds_read_b128 v[20:23], v6
L_ftile:
    s_waitcnt lgkmcnt(0)
    v_perm_b32 v96, v196, v192, s49
    v_perm_b32 v97, v204, v200, s49
    v_perm_b32 v98, v212, v208, s49
    v_perm_b32 v99, v220, v216, s49
    v_perm_b32 v100, v196, v192, s50
    v_perm_b32 v101, v204, v200, s50
    v_perm_b32 v102, v212, v208, s50
    v_perm_b32 v103, v220, v216, s50
    v_perm_b32 v104, v197, v193, s49
    v_perm_b32 v105, v205, v201, s49
    v_perm_b32 v106, v213, v209, s49
    v_perm_b32 v107, v221, v217, s49
    v_perm_b32 v108, v197, v193, s50
    v_perm_b32 v109, v205, v201, s50
    v_perm_b32 v110, v213, v209, s50
    v_perm_b32 v111, v221, v217, s50
    v_perm_b32 v112, v198, v194, s49
    v_perm_b32 v113, v206, v202, s49
    v_perm_b32 v114, v214, v210, s49
    v_perm_b32 v115, v222, v218, s49
    v_perm_b32 v116, v198, v194, s50
    v_perm_b32 v117, v206, v202, s50
    v_perm_b32 v118, v214, v210, s50
    v_perm_b32 v119, v222, v218, s50
    v_perm_b32 v120, v199, v195, s49
    v_perm_b32 v121, v207, v203, s49
    v_perm_b32 v122, v215, v211, s49
    v_perm_b32 v123, v223, v219, s49
    v_perm_b32 v124, v199, v195, s50
    v_perm_b32 v125, v207, v203, s50
    v_perm_b32 v126, v215, v211, s50
    v_perm_b32 v127, v223, v219, s50
    v_mfma_f32_16x16x32_bf16 v[128:131], v[20:23], v[96:99], 0
    v_mfma_f32_16x16x32_bf16 v[132:135], v[20:23], v[100:103], 0
    v_mfma_f32_16x16x32_bf16 v[136:139], v[20:23], v[104:107], 0
    v_mfma_f32_16x16x32_bf16 v[140:143], v[20:23], v[108:111], 0
    v_mfma_f32_16x16x32_bf16 v[144:147], v[20:23], v[112:115], 0
    v_mfma_f32_16x16x32_bf16 v[148:151], v[20:23], v[116:119], 0
    v_mfma_f32_16x16x32_bf16 v[152:155], v[20:23], v[120:123], 0
    v_mfma_f32_16x16x32_bf16 v[156:159], v[20:23], v[124:127], 0
    v_add_u32 v5, 2048, v29
    v_add_u32 v6, 4096, v29
    s_mov_b64 exec, 0xffff
    ds_write2_b32 v5, v128, v132 offset0:0 offset1:1
    ds_write2_b32 v5, v136, v140 offset0:2 offset1:3
    s_nop 0
    ds_write2_b32 v5, v144, v148 offset0:4 offset1:5
    s_nop 0
    ds_write2_b32 v5, v152, v156 offset0:6 offset1:7
    ds_write2_b32 v6, v129, v133 offset0:0 offset1:1
    ds_write2_b32 v6, v137, v141 offset0:2 offset1:3
    ds_write2_b32 v6, v145, v149 offset0:4 offset1:5
    ds_write2_b32 v6, v153, v157 offset0:6 offset1:7
    s_mov_b64 exec, 1
    s_waitcnt lgkmcnt(0)
    ds_add_rtn_u32 v27, v24, v25 offset:268
    s_waitcnt lgkmcnt(0)
    v_readfirstlane_b32 s54, v27
    s_mov_b64 exec, -1
    s_cmp_eq_u32 s54, 3
    s_cbranch_scc0 L_role
    v_lshlrev_b32 v5, 2, v1
    v_add_u32 v5, 4096, v5
    ds_read2st64_b32 v[80:81], v5 offset0:0 offset1:8
    ds_read2st64_b32 v[82:83], v5 offset0:2 offset1:10
    ds_read2st64_b32 v[84:85], v5 offset0:4 offset1:12
    ds_read2st64_b32 v[86:87], v5 offset0:6 offset1:14
    ds_read2st64_b32 v[88:89], v5 offset0:1 offset1:9
    ds_read2st64_b32 v[90:91], v5 offset0:3 offset1:11
    ds_read2st64_b32 v[92:93], v5 offset0:5 offset1:13
    ds_read2st64_b32 v[94:95], v5 offset0:7 offset1:15
    s_waitcnt lgkmcnt(0)
    v_pk_add_f32 v[80:81], v[80:81], v[82:83]
    v_pk_add_f32 v[84:85], v[84:85], v[86:87]
    v_mov_b32 v82, s46
    v_pk_add_f32 v[80:81], v[80:81], v[84:85]
    v_pk_add_f32 v[88:89], v[88:89], v[90:91]
    v_pk_add_f32 v[92:93], v[92:93], v[94:95]
    v_mov_b32 v90, s46
    v_pk_add_f32 v[88:89], v[88:89], v[92:93]
    s_lshl_b32 s54, s95, 11
    v_lshl_add_u32 v84, v1, 4, s54
    s_lshr_b32 s59, s94, 1
    s_cbranch_scc1 L_role
    v_add_u32 v5, 589824, v84
    s_cmp_lg_u32 s45, 0
    s_cbranch_scc1 L_sgx
    global_store_dwordx4 v5, v[80:83], s[30:31]
    global_store_dwordx4 v5, v[88:91], s[30:31] offset:1024
    s_branch L_sgy
L_sgx:
    global_store_dwordx4 v5, v[80:83], s[30:31] sc1
    global_store_dwordx4 v5, v[88:91], s[30:31] offset:1024 sc1
L_sgy:
L_role:
    s_mul_i32 s54, s4, 544
    v_add_u32 v96, s54, v28
    s_lshl_b32 s55, s4, 4
    v_mov_b32 v97, s55
    s_lshl_b32 s56, s35, 15
    s_add_u32 s56, s56, 1048576
    s_lshl_b32 s57, s4, 13
    s_add_u32 s57, s57, s56
    s_lshl_b32 s58, s34, 7
    s_add_u32 s57, s57, s58
    v_lshlrev_b32 v7, 4, v3
    v_lshl_add_u32 v6, v2, 12, v7
    v_lshrrev_b32 v6, 1, v6
    v_add_u32 v98, s57, v6
    v_lshl_add_u32 v99, v2, 11, v7
    s_lshl_b32 s58, s7, 11
    s_add_u32 s56, s56, s58
    v_lshl_add_u32 v100, v1, 3, s56
    s_lshl_b32 s56, s35, 2
    s_add_u32 s56, s56, s5
    s_lshl_b32 s56, s56, 12
    s_lshl_b32 s57, s6, 10
    s_add_u32 s56, s56, s57
    s_add_u32 s56, s56, 262144
    v_lshl_add_u32 v101, v1, 4, s56
    v_mov_b32 v50, s46
    v_mov_b32 v102, 1.0
    v_mov_b32 v47, s46
    v_mov_b32 v112, 0x3f80
    v_mov_b32 v116, 1.0
    v_mov_b32 v113, 0x3f80
    v_mov_b32 v117, 1.0
    v_mov_b32 v114, 0x3f80
    v_mov_b32 v118, 1.0
    v_mov_b32 v115, 0x3f80
    v_mov_b32 v119, 1.0
    s_bfe_u32 s93, s2, 0x10006
    s_and_b32 s57, s2, 63
    v_and_b32 v8, 3, v1
    v_lshrrev_b32 v9, 2, v1
    v_lshlrev_b32 v9, 12, v9
    v_lshl_add_u32 v9, v8, 4, v9
    s_lshl_b32 s54, s57, 6
    s_lshl_b32 s55, s93, 17
    s_add_u32 s55, s55, s54
    s_add_u32 s55, s55, 262144
    v_add_u32 v106, s55, v9
    v_add_u32 v107, 0x10000, v106
    v_lshrrev_b32 v9, 5, v1
    v_lshl_add_u32 v9, v8, 1, v9
    s_and_b32 s54, s2, 127
    s_lshl_b32 s54, s54, 4
    v_lshl_add_u32 v105, v9, 1, s54
    v_lshlrev_b32 v108, 2, v9
    s_lshl_b32 s54, s57, 7
    s_add_u32 s54, s54, 131072
    v_lshrrev_b32 v9, 3, v1
    v_lshlrev_b32 v9, 13, v9
    v_and_b32 v8, 7, v1
    v_lshl_add_u32 v9, v8, 4, v9
    v_add_u32 v110, s54, v9
    v_add_u32 v111, 0x10000, v110
    s_mov_b64 s[36:37], s[16:17]
    s_lshl_b32 s56, s6, 8
    s_lshl_b32 s92, s32, 4
    s_add_u32 s92, s92, s7
    s_lshl_b32 s92, s92, 15
    s_add_u32 s92, s92, s56
    s_cmp_eq_u32 s4, 3
    s_cbranch_scc1 L_bal
    s_cmp_eq_u32 s4, 0
    s_cbranch_scc1 L_stat
    s_cmp_eq_u32 s4, 1
    s_cbranch_scc0 L_bump
    global_load_ushort v104, v105, s[8:9]
    s_waitcnt vmcnt(0)
    v_lshlrev_b32 v104, 16, v104
    s_branch L_tail
L_bump:
    s_cmp_eq_u32 s2, 64
    s_cbranch_scc0 L_tk
    s_mov_b32 s58, 1048576
L_wb:
    ds_read_b32 v27, v24 offset:0
    s_waitcnt lgkmcnt(0)
    v_cmp_gt_u32 vcc, 40, v27
    s_cbranch_vccz L_wbd
    s_sleep 16
    s_sub_u32 s58, s58, 1
    s_cbranch_scc0 L_wb
L_wbd:
    v_lshlrev_b32 v4, 9, v1
    v_add_u32 v5, 0x8000, v4
    v_add_u32 v6, 0x10000, v4
    v_add_u32 v7, 0x18000, v4
    s_mov_b32 s58, 1048576
    s_mov_b64 s[80:81], -1
    s_mov_b64 s[82:83], -1
    s_mov_b64 s[84:85], -1
    s_mov_b64 s[86:87], -1
L_p3:
    s_wqm_b64 exec, s[80:81]
    s_cbranch_execz L_p3s0
    global_load_dword v16, v4, s[30:31] offset:8 sc1
L_p3s0:
    s_wqm_b64 exec, s[82:83]
    s_cbranch_execz L_p3s1
    global_load_dword v17, v5, s[30:31] offset:8 sc1
L_p3s1:
    s_wqm_b64 exec, s[84:85]
    s_cbranch_execz L_p3s2
    global_load_dword v18, v6, s[30:31] offset:8 sc1
L_p3s2:
    s_wqm_b64 exec, s[86:87]
    s_cbranch_execz L_p3s3
    global_load_dword v19, v7, s[30:31] offset:8 sc1
L_p3s3:
    s_waitcnt vmcnt(0)
    s_wqm_b64 exec, s[80:81]
    v_cmp_ne_u32 s[80:81], s46, v16
    s_wqm_b64 exec, s[82:83]
    v_cmp_ne_u32 s[82:83], s46, v17
    s_wqm_b64 exec, s[84:85]
    v_cmp_ne_u32 s[84:85], s46, v18
    s_wqm_b64 exec, s[86:87]
    v_cmp_ne_u32 s[86:87], s46, v19
    s_mov_b64 exec, -1
    s_or_b64 vcc, s[80:81], s[80:81]
    s_or_b64 vcc, vcc, s[82:83]
    s_or_b64 vcc, vcc, s[84:85]
    s_or_b64 vcc, vcc, s[86:87]
    s_cbranch_scc0 L_p3d
    s_sleep 16
    s_sub_u32 s58, s58, 1
    s_cbranch_scc0 L_p3
L_p3d:
    s_mov_b64 exec, 1
    v_mov_b32 v4, 524288
    global_store_dword v4, v50, s[30:31] sc1
    s_mov_b64 exec, -1
L_tk:
    s_cmp_lg_u32 s45, 0
    s_cbranch_scc1 L_tail
    s_lshr_b32 s47, s2, 3
    s_sub_u32 s57, 31, s47
    s_mul_i32 s56, s57, 13
    s_add_u32 s56, s56, 12
    s_sub_u32 s57, s56, 12
    s_add_u32 s60, s56, 5
    s_mov_b32 s58, 1048576
L_t0:
    ds_read_b32 v27, v24 offset:276
    s_waitcnt lgkmcnt(0)
    v_cmp_gt_u32 vcc, s57, v27
    s_cbranch_vccz L_t0d
    s_sleep 8
    s_sub_u32 s58, s58, 1
    s_cbranch_scc0 L_t0
L_t0d:
    s_mov_b32 s58, 1048576
L_t1:
    ds_read_b32 v27, v24 offset:276
    s_waitcnt lgkmcnt(0)
    v_cmp_gt_u32 vcc, s56, v27
    s_cbranch_vccz L_t1d
    s_sleep 1
    s_sub_u32 s58, s58, 1
    s_cbranch_scc0 L_t1
L_t1d:
    s_mov_b32 s62, 1
    s_atomic_add s62, s[30:31], s98
    s_mov_b32 s58, 1048576
L_t2:
    ds_read_b32 v27, v24 offset:276
    s_waitcnt lgkmcnt(0)
    v_cmp_gt_u32 vcc, s60, v27
    s_cbranch_vccz L_t2d
    s_sleep 1
    s_sub_u32 s58, s58, 1
    s_cbranch_scc0 L_t2
L_t2d:
    s_mov_b32 s54, 0
    s_atomic_add s54, s[30:31], s98 glc
    s_mul_i32 s55, s32, 4352
    s_add_u32 s55, s55, 2261120
    v_mov_b32 v7, s55
    s_waitcnt lgkmcnt(0)
    s_sub_u32 s54, s54, 1
    s_min_u32 s54, s54, 7
    s_lshl_b32 s54, s54, 2
    s_lshr_b32 s54, 0x24688aa, s54
    s_and_b32 s54, s54, 15
    s_add_u32 s54, s54, s46
    s_mov_b64 exec, 1
    v_mov_b32 v13, s54
    global_store_dword v7, v13, s[30:31]
    s_mov_b64 exec, -1
    s_branch L_tail
L_stat:
    s_mov_b32 s58, 1048576
L_wk:
    ds_read_b32 v27, v24 offset:272
    s_waitcnt lgkmcnt(0)
    v_cmp_gt_u32 vcc, 4, v27
    s_cbranch_vccz L_wkd
    s_sleep 16
    s_sub_u32 s58, s58, 1
    s_cbranch_scc0 L_wk
L_wkd:
    v_and_b32 v4, 15, v1
    v_lshlrev_b32 v4, 2, v4
    ds_read_b32 v8, v4 offset:320
    v_lshlrev_b32 v5, 4, v1
    v_add_u32 v5, 17408, v5
    s_mov_b32 s48, 15
    v_mov_b32 v10, 0
    v_mov_b32 v11, 0
    s_waitcnt lgkmcnt(0)
    v_mov_b32 v9, v8
    s_nop 1
    v_max_f32_dpp v9, v9, v9 row_ror:4 row_mask:0xf bank_mask:0xf
    s_nop 1
    v_max_f32_dpp v9, v9, v9 row_ror:8 row_mask:0xf bank_mask:0xf
L_sum:
    ds_read_b128 v[16:19], v5
    v_add_u32 v5, 0x400, v5
    s_waitcnt lgkmcnt(0)
    v_lshlrev_b32 v224, 16, v16
    v_and_b32 v225, s51, v16
    v_lshlrev_b32 v226, 16, v17
    v_and_b32 v227, s51, v17
    v_lshlrev_b32 v228, 16, v18
    v_and_b32 v229, s51, v18
    v_lshlrev_b32 v230, 16, v19
    v_and_b32 v231, s51, v19
    v_fma_f32 v224, v224, s53, -v9
    v_fma_f32 v225, v225, s53, -v9
    v_fma_f32 v226, v226, s53, -v9
    v_fma_f32 v227, v227, s53, -v9
    v_fma_f32 v228, v228, s53, -v9
    v_fma_f32 v229, v229, s53, -v9
    v_fma_f32 v230, v230, s53, -v9
    v_fma_f32 v231, v231, s53, -v9
    v_exp_f32 v224, v224
    v_exp_f32 v225, v225
    v_exp_f32 v226, v226
    v_exp_f32 v227, v227
    v_exp_f32 v228, v228
    v_exp_f32 v229, v229
    v_exp_f32 v230, v230
    v_exp_f32 v231, v231
    v_pk_add_f32 v[10:11], v[10:11], v[224:225]
    v_pk_add_f32 v[10:11], v[10:11], v[226:227]
    v_pk_add_f32 v[10:11], v[10:11], v[228:229]
    v_pk_add_f32 v[10:11], v[10:11], v[230:231]
    s_sub_u32 s48, s48, 1
    s_cbranch_scc0 L_sum
    v_add_f32 v10, v10, v11
    s_nop 1
    v_add_f32_dpp v10, v10, v10 row_ror:4 row_mask:0xf bank_mask:0xf
    s_nop 1
    v_add_f32_dpp v10, v10, v10 row_ror:8 row_mask:0xf bank_mask:0xf
    v_mov_b32 v13, v10
    s_nop 1
    v_permlane32_swap_b32 v10, v13
    v_add_f32 v10, v10, v13
    v_mov_b32 v13, v10
    s_nop 1
    v_permlane16_swap_b32 v10, v13
    v_add_f32 v10, v10, v13
    v_log_f32 v10, v10
    v_mov_b32 v11, s46
    s_lshl_b32 s54, s35, 9
    s_add_u32 s54, s54, 245760
    v_add_u32 v5, s54, v28
    s_lshl_b32 s55, s34, 5
    v_add_u32 v6, s55, v5
    v_add_f32 v10, v10, v9
    s_mov_b64 exec, 15
    s_cmp_lg_u32 s45, 0
    s_cbranch_scc1 L_ssx
    global_store_dwordx2 v6, v[10:11], s[30:31]
    s_branch L_ssy
L_ssx:
    global_store_dwordx2 v6, v[10:11], s[30:31] sc1
L_ssy:
    s_mov_b64 exec, -1
    s_mov_b32 s58, 1048576
L_ps:
    global_load_dwordx2 v[14:15], v5, s[30:31] sc1
    s_waitcnt vmcnt(0)
    v_cmp_ne_u32 vcc, s46, v15
    s_cbranch_vccz L_psd
    s_sleep 16
    s_sub_u32 s58, s58, 1
    s_cbranch_scc0 L_ps
L_psd:
    v_mov_b32 v9, v14
    s_nop 1
    v_max_f32_dpp v9, v9, v9 row_ror:4 row_mask:0xf bank_mask:0xf
    s_nop 1
    v_max_f32_dpp v9, v9, v9 row_ror:8 row_mask:0xf bank_mask:0xf
    v_mov_b32 v13, v9
    s_nop 1
    v_permlane32_swap_b32 v9, v13
    v_max_f32 v9, v9, v13
    v_mov_b32 v13, v9
    s_nop 1
    v_permlane16_swap_b32 v9, v13
    v_max_f32 v9, v9, v13
    v_sub_f32 v14, v14, v9
    v_exp_f32 v14, v14
    s_nop 1
    v_add_f32_dpp v14, v14, v14 row_ror:4 row_mask:0xf bank_mask:0xf
    s_nop 1
    v_add_f32_dpp v14, v14, v14 row_ror:8 row_mask:0xf bank_mask:0xf
    v_mov_b32 v13, v14
    s_nop 1
    v_permlane32_swap_b32 v14, v13
    v_add_f32 v14, v14, v13
    v_mov_b32 v13, v14
    s_nop 1
    v_permlane16_swap_b32 v14, v13
    v_add_f32 v14, v14, v13
    v_sub_f32 v8, v8, v9
    v_exp_f32 v8, v8
    v_rcp_f32 v14, v14
    v_and_b32 v4, 3, v1
    v_and_b32 v5, 12, v1
    v_lshl_add_u32 v4, v4, 4, v5
    v_mul_f32 v8, v8, v14
    ds_write_b32 v4, v8 offset:384
    s_branch L_tail
L_bal:
    s_cmp_lg_u32 s45, 0
    s_cbranch_scc1 L_tail
    s_lshr_b32 s47, s2, 3
    s_mul_i32 s54, s32, 4352
    s_add_u32 s54, s54, 2260992
    v_min_u32 v5, 32, v1
    v_lshl_add_u32 v5, v5, 2, s54
    s_lshl_b32 s55, s47, 2
    s_add_u32 s55, s55, s54
    v_mov_b32 v6, s55
    s_add_u32 s55, s54, 128
    v_mov_b32 v7, s55
    s_mov_b32 s58, 1048576
    s_mov_b32 s61, 0
    v_not_b32 v14, s46
    s_mov_b32 s42, 0
L_ctl:
    ds_read_b32 v27, v24 offset:0
    s_waitcnt vmcnt(12)
    v_subrev_u32 v12, s46, v14
    s_mov_b32 exec_hi, 1
    global_load_dword v14, v5, s[30:31] nt
    s_mov_b64 exec, 1
    s_waitcnt lgkmcnt(0)
    v_readfirstlane_b32 s57, v27
    s_and_b32 s54, s58, 63
    s_lshl_b32 s54, s54, 10
    s_add_u32 s54, s54, s46
    v_add_u32 v13, s54, v27
    global_store_dword v6, v13, s[30:31]
    s_mov_b64 exec, -1
    v_cmp_lt_u32 vcc, 0xffff, v12
    v_readlane_b32 s40, v12, s47
    v_readlane_b32 s63, v12, 32
    v_and_b32 v12, 0x3ff, v12
    s_and_b32 s61, s40, 0x3ff
    s_lshr_b32 s40, s40, 10
    s_sub_u32 s40, s40, s58
    s_and_b32 s40, s40, 63
    s_mul_i32 s40, s40, 50
    s_sub_i32 s41, s57, s61
    s_lshl_b32 s41, s41, 4
    s_sub_i32 s40, s41, s40
    s_cmp_eq_u32 vcc_lo, 0
    s_cselect_b32 s40, s40, s42
    s_sub_i32 s40, s40, s42
    s_ashr_i32 s41, s40, 4
    s_add_i32 s42, s42, s41
    s_add_i32 s40, s40, 8
    s_ashr_i32 s40, s40, 4
    s_add_i32 s61, s61, s40
    v_add_u32_dpp v12, v12, v12 row_ror:8 row_mask:0xf bank_mask:0xf
    s_nop 1
    v_add_u32_dpp v12, v12, v12 row_ror:4 row_mask:0xf bank_mask:0xf
    s_nop 1
    v_add_u32_dpp v12, v12, v12 row_ror:2 row_mask:0xf bank_mask:0xf
    s_nop 1
    v_add_u32_dpp v12, v12, v12 row_ror:1 row_mask:0xf bank_mask:0xf
    s_nop 0
    v_readlane_b32 s54, v12, 0
    v_readlane_b32 s55, v12, 16
    s_nop 0
    s_add_u32 s54, s54, s55
    s_add_u32 s54, s54, 16
    s_lshr_b32 s54, s54, 5
    s_sub_i32 s61, s61, s54
    s_cmp_eq_u32 vcc_lo, 0
    s_cselect_b32 s61, s61, 0
    s_cmp_lt_u32 s63, 16
    s_cselect_b32 s63, s63, 0
    s_add_i32 s63, s63, s61
    v_mov_b32 v12, s63
    ds_write_b32 v24, v12 offset:256
    s_sub_i32 s55, s57, s61
    v_mov_b32 v13, s55
    ds_write_b32 v24, v13 offset:276
    s_sub_u32 s58, s58, 1
    s_cbranch_scc1 L_cte
    s_cmp_lt_u32 s57, 446
    s_cbranch_scc1 L_ctl
L_cte:
    v_mov_b32 v13, 0x7fff
    ds_write_b32 v24, v13 offset:276
L_tail:
    s_mov_b32 s58, 1048576
L_wn:
    ds_read_b32 v27, v24 offset:0
    s_waitcnt lgkmcnt(0)
    v_cmp_gt_u32 vcc, 424, v27
    s_cbranch_vccz L_wnd
    s_sleep 16
    s_sub_u32 s58, s58, 1
    s_cbranch_scc0 L_wn
L_wnd:
    s_cmp_eq_u32 s4, 1
    s_cbranch_scc0 L_nw
    global_load_dword v16, v101, s[30:31] sc1
    s_mov_b64 exec, 1
    buffer_load_dword v17, v24, s[36:39], s92 offen
    s_mov_b64 exec, -1
L_nw:
    s_mov_b32 s58, 1048576
L_wo:
    ds_read_b32 v27, v24 offset:0
    s_waitcnt lgkmcnt(0)
    v_cmp_gt_u32 vcc, 16838, v27
    s_cbranch_vccz L_wod
    s_sleep 1
    s_sub_u32 s58, s58, 1
    s_cbranch_scc0 L_wo
L_wod:
    s_cmp_eq_u32 s59, 0
    s_cbranch_scc1 L_nofs
    v_add_u32 v8, 131072, v84
    global_store_dwordx4 v8, v[80:83], s[30:31] sc1
    global_store_dwordx4 v8, v[88:91], s[30:31] offset:1024 sc1
L_nofs:
    buffer_load_dwordx4 v[192:195], v99, s[36:39], s92 offen
    buffer_load_dwordx4 v[208:211], v99, s[36:39], s92 offen offset:1024
    s_xor_b32 s92, s92, 0x2000
    buffer_load_dwordx4 v[196:199], v99, s[36:39], s92 offen
    buffer_load_dwordx4 v[212:215], v99, s[36:39], s92 offen offset:1024
    s_xor_b32 s92, s92, 0x6000
    buffer_load_dwordx4 v[200:203], v99, s[36:39], s92 offen
    buffer_load_dwordx4 v[216:219], v99, s[36:39], s92 offen offset:1024
    s_xor_b32 s92, s92, 0x2000
    buffer_load_dwordx4 v[204:207], v99, s[36:39], s92 offen
    buffer_load_dwordx4 v[220:223], v99, s[36:39], s92 offen offset:1024
    global_load_dwordx2 v[64:65], v100, s[30:31] offset:0 sc1
    global_load_dwordx2 v[66:67], v100, s[30:31] offset:512 sc1
    global_load_dwordx2 v[68:69], v100, s[30:31] offset:1024 sc1
    global_load_dwordx2 v[70:71], v100, s[30:31] offset:1536 sc1
    s_barrier
    ds_read_b128 v[40:43], v97 offset:384
    ds_read_b64 v[32:33], v96 offset:8192
    ds_read_b64 v[34:35], v96 offset:10368
    ds_read_b64 v[36:37], v96 offset:12544
    ds_read_b64 v[38:39], v96 offset:14720
    s_waitcnt lgkmcnt(0)
    v_pk_mul_f32 v[48:49], v[32:33], v[40:41] op_sel_hi:[1,0]
    v_pk_mul_f32 v[44:45], v[36:37], v[42:43] op_sel_hi:[1,0]
    v_pk_fma_f32 v[48:49], v[34:35], v[40:41], v[48:49] op_sel:[0,1,0] op_sel_hi:[1,1,1]
    v_pk_fma_f32 v[44:45], v[38:39], v[42:43], v[44:45] op_sel:[0,1,0] op_sel_hi:[1,1,1]
    v_pk_add_f32 v[48:49], v[48:49], v[44:45]
    v_cvt_pk_bf16_f32 v46, v48, v49
    s_cmp_lg_u32 s45, 0
    s_cbranch_scc1 L_shx
    global_store_dwordx2 v98, v[46:47], s[30:31]
    s_branch L_shy
L_shx:
    global_store_dwordx2 v98, v[46:47], s[30:31] sc1
L_shy:
    s_waitcnt vmcnt(1)
    v_cmp_ne_u32 s[80:81], s46, v65
    v_cmp_ne_u32 s[82:83], s46, v67
    v_cmp_ne_u32 s[84:85], s46, v69
    v_cmp_ne_u32 s[86:87], s46, v71
    s_wqm_b64 exec, s[80:81]
    s_or_b32 exec_lo, exec_lo, 1
    global_load_dwordx2 v[64:65], v100, s[30:31] offset:0 sc1
    s_wqm_b64 exec, s[82:83]
    s_or_b32 exec_lo, exec_lo, 1
    global_load_dwordx2 v[66:67], v100, s[30:31] offset:512 sc1
    s_wqm_b64 exec, s[84:85]
    s_or_b32 exec_lo, exec_lo, 1
    global_load_dwordx2 v[68:69], v100, s[30:31] offset:1024 sc1
    s_wqm_b64 exec, s[86:87]
    s_or_b32 exec_lo, exec_lo, 1
    global_load_dwordx2 v[70:71], v100, s[30:31] offset:1536 sc1
    s_mov_b64 exec, -1
    v_perm_b32 v160, v196, v192, s49
    v_perm_b32 v161, v204, v200, s49
    v_perm_b32 v162, v212, v208, s49
    v_perm_b32 v163, v220, v216, s49
    v_perm_b32 v164, v196, v192, s50
    v_perm_b32 v165, v204, v200, s50
    v_perm_b32 v166, v212, v208, s50
    v_perm_b32 v167, v220, v216, s50
    v_perm_b32 v168, v197, v193, s49
    v_perm_b32 v169, v205, v201, s49
    v_perm_b32 v170, v213, v209, s49
    v_perm_b32 v171, v221, v217, s49
    v_perm_b32 v172, v197, v193, s50
    v_perm_b32 v173, v205, v201, s50
    v_perm_b32 v174, v213, v209, s50
    v_perm_b32 v175, v221, v217, s50
    v_perm_b32 v176, v198, v194, s49
    v_perm_b32 v177, v206, v202, s49
    v_perm_b32 v178, v214, v210, s49
    v_perm_b32 v179, v222, v218, s49
    v_perm_b32 v180, v198, v194, s50
    v_perm_b32 v181, v206, v202, s50
    v_perm_b32 v182, v214, v210, s50
    v_perm_b32 v183, v222, v218, s50
    v_perm_b32 v184, v199, v195, s49
    v_perm_b32 v185, v207, v203, s49
    v_perm_b32 v186, v215, v211, s49
    v_perm_b32 v187, v223, v219, s49
    v_perm_b32 v188, v199, v195, s50
    v_perm_b32 v189, v207, v203, s50
    v_perm_b32 v190, v215, v211, s50
    v_perm_b32 v191, v223, v219, s50
    s_mov_b32 s58, 1048576
L_p1:
    s_waitcnt vmcnt(0)
    v_cmp_ne_u32 s[80:81], s46, v65
    v_cmp_ne_u32 s[82:83], s46, v67
    v_cmp_ne_u32 s[84:85], s46, v69
    v_cmp_ne_u32 s[86:87], s46, v71
    s_or_b64 vcc, s[80:81], s[82:83]
    s_or_b64 vcc, vcc, s[84:85]
    s_or_b64 vcc, vcc, s[86:87]
    s_cbranch_scc0 L_p1d
    s_wqm_b64 exec, s[80:81]
    s_or_b32 exec_lo, exec_lo, 1
    global_load_dwordx2 v[64:65], v100, s[30:31] offset:0 sc1
    s_wqm_b64 exec, s[82:83]
    s_or_b32 exec_lo, exec_lo, 1
    global_load_dwordx2 v[66:67], v100, s[30:31] offset:512 sc1
    s_wqm_b64 exec, s[84:85]
    s_or_b32 exec_lo, exec_lo, 1
    global_load_dwordx2 v[68:69], v100, s[30:31] offset:1024 sc1
    s_wqm_b64 exec, s[86:87]
    s_or_b32 exec_lo, exec_lo, 1
    global_load_dwordx2 v[70:71], v100, s[30:31] offset:1536 sc1
    s_mov_b64 exec, -1
    s_sub_u32 s58, s58, 1
    s_cbranch_scc0 L_p1
    s_waitcnt vmcnt(0)
L_p1d:
    v_mov_b32 v65, v68
    v_mov_b32 v67, v70
    s_nop 1
    v_mfma_f32_16x16x32_bf16 v[52:55], v[64:67], v[112:115], 0
    v_mfma_f32_16x16x32_bf16 v[56:59], v[64:67], v[116:119], 0
    s_nop 7
    v_cvt_pk_bf16_f32 v20, v52, v56
    v_cvt_pk_bf16_f32 v21, v53, v57
    v_cvt_pk_bf16_f32 v22, v54, v58
    v_cvt_pk_bf16_f32 v23, v55, v59
    s_nop 1
    v_mfma_f32_16x16x32_bf16 v[128:131], v[20:23], v[160:163], 0
    v_mfma_f32_16x16x32_bf16 v[132:135], v[20:23], v[164:167], 0
    v_mfma_f32_16x16x32_bf16 v[136:139], v[20:23], v[168:171], 0
    v_mfma_f32_16x16x32_bf16 v[140:143], v[20:23], v[172:175], 0
    v_mfma_f32_16x16x32_bf16 v[144:147], v[20:23], v[176:179], 0
    v_mfma_f32_16x16x32_bf16 v[148:151], v[20:23], v[180:183], 0
    v_mfma_f32_16x16x32_bf16 v[152:155], v[20:23], v[184:187], 0
    v_mfma_f32_16x16x32_bf16 v[156:159], v[20:23], v[188:191], 0
    s_mov_b64 exec, 0xffff
    s_nop 0
    ds_write2_b32 v29, v128, v132 offset0:0 offset1:1
    s_nop 0
    ds_write2_b32 v29, v136, v140 offset0:2 offset1:3
    s_nop 0
    ds_write2_b32 v29, v144, v148 offset0:4 offset1:5
    s_nop 0
    ds_write2_b32 v29, v152, v156 offset0:6 offset1:7
    s_mov_b64 exec, -1
    s_waitcnt lgkmcnt(0)
    s_barrier
    s_cmp_eq_u32 s4, 0
    s_cbranch_scc0 L_fin
    ds_read_b64 v[8:9], v28 offset:2048
    ds_read_b64 v[10:11], v28 offset:2560
    ds_read_b64 v[12:13], v28 offset:3072
    ds_read_b64 v[14:15], v28 offset:3584
    s_waitcnt lgkmcnt(0)
    v_pk_add_f32 v[8:9], v[8:9], v[10:11]
    v_pk_add_f32 v[12:13], v[12:13], v[14:15]
    v_mov_b32 v10, s46
    v_pk_add_f32 v[8:9], v[8:9], v[12:13]
    global_store_dwordx4 v101, v[8:11], s[30:31] sc1
    s_branch L_end
L_fin:
    s_cmp_lt_u32 s2, 128
    s_cbranch_scc0 L_end
    s_cmp_eq_u32 s4, 1
    s_cbranch_scc0 L_end
    v_mov_b32 v20, 0
    v_mov_b32 v21, 0
    s_mov_b32 s58, 1048576
    s_mov_b64 s[80:81], -1
    s_mov_b32 s82, 0xffffffff
    s_mov_b32 s83, 0xffff
L_pf:
    s_wqm_b64 exec, s[80:81]
    s_cbranch_execz L_pfs0
    global_load_dwordx4 v[16:19], v110, s[30:31] sc1
L_pfs0:
    s_wqm_b64 exec, s[82:83]
    s_cbranch_execz L_pfs1
    global_load_dwordx4 v[20:23], v111, s[30:31] sc1
L_pfs1:
    s_waitcnt vmcnt(0)
    s_wqm_b64 exec, s[80:81]
    v_cmp_ne_u32 s[80:81], s46, v18
    s_wqm_b64 exec, s[82:83]
    v_cmp_ne_u32 s[82:83], s46, v22
    s_mov_b64 exec, -1
    s_or_b64 vcc, s[80:81], s[80:81]
    s_or_b64 vcc, vcc, s[82:83]
    s_cbranch_scc0 L_pfd
    s_sub_u32 s58, s58, 1
    s_cbranch_scc0 L_pf
L_pfd:
    global_load_dwordx4 v[32:35], v106, s[30:31] sc1
    global_load_dwordx4 v[36:39], v107, s[30:31] sc1
    v_pk_add_f32 v[16:17], v[16:17], v[20:21]
    s_cmp_eq_u32 s93, 0
    s_cselect_b64 vcc, 0, -1
    v_cndmask_b32 v8, v16, v17, vcc
    s_nop 1
    v_add_f32_dpp v8, v8, v8 row_ror:8 row_mask:0xf bank_mask:0xf
    v_mov_b32 v9, v8
    s_nop 1
    v_permlane32_swap_b32 v8, v9
    v_add_f32 v8, v8, v9
    v_mov_b32 v9, v8
    s_nop 1
    v_permlane16_swap_b32 v8, v9
    v_add_f32 v8, v8, v9
    v_cvt_pk_bf16_f32 v8, v8, v8
    v_and_b32 v8, s51, v8
    v_mul_f32 v9, s53, v8
    v_exp_f32 v9, -v9
    s_nop 0
    v_add_f32 v9, 1.0, v9
    v_rcp_f32 v9, v9
    s_nop 0
    v_mul_f32 v8, v8, v9
    v_cvt_pk_bf16_f32 v8, v8, v8
    v_and_b32 v8, s51, v8
    ds_bpermute_b32 v10, v108, v8
    s_mov_b64 s[84:85], -1
    s_mov_b64 s[86:87], -1
    s_mov_b32 s58, 1048576
L_p2:
    s_wqm_b64 exec, s[84:85]
    s_or_b32 exec_lo, exec_lo, 1
    global_load_dwordx4 v[40:43], v106, s[30:31] sc1
    s_wqm_b64 exec, s[86:87]
    s_or_b32 exec_lo, exec_lo, 1
    global_load_dwordx4 v[44:47], v107, s[30:31] sc1
    s_mov_b64 exec, -1
    s_waitcnt vmcnt(2)
    v_cmp_ne_u32 s[80:81], s46, v34
    v_cmp_ne_u32 s[82:83], s46, v38
    s_nop 0
    s_or_b64 vcc, s[80:81], s[82:83]
    s_cbranch_scc0 L_p2d
    s_wqm_b64 exec, s[80:81]
    s_or_b32 exec_lo, exec_lo, 1
    global_load_dwordx4 v[32:35], v106, s[30:31] sc1
    s_wqm_b64 exec, s[82:83]
    s_or_b32 exec_lo, exec_lo, 1
    global_load_dwordx4 v[36:39], v107, s[30:31] sc1
    s_mov_b64 exec, -1
    s_waitcnt vmcnt(2)
    v_cmp_ne_u32 s[84:85], s46, v42
    v_cmp_ne_u32 s[86:87], s46, v46
    s_nop 0
    s_or_b64 vcc, s[84:85], s[86:87]
    s_cbranch_scc0 L_p2b
    s_sub_u32 s58, s58, 1
    s_cbranch_scc0 L_p2
L_p2b:
    v_pk_add_f32 v[16:17], v[40:41], v[44:45]
    s_branch L_p2e
L_p2d:
    v_pk_add_f32 v[16:17], v[32:33], v[36:37]
    s_nop 0
L_p2e:
    s_nop 0
    v_permlane32_swap_b32 v16, v17
    v_add_f32 v8, v16, v17
    v_mov_b32 v9, v8
    s_nop 1
    v_permlane16_swap_b32 v8, v9
    v_add_f32 v8, v8, v9
    s_nop 1
    v_add_f32_dpp v8, v8, v8 row_ror:4 row_mask:0xf bank_mask:0xf
    s_nop 1
    v_add_f32_dpp v8, v8, v8 row_ror:8 row_mask:0xf bank_mask:0xf
    v_cvt_pk_bf16_f32 v8, v8, v8
    v_and_b32 v8, s51, v8
    s_waitcnt lgkmcnt(0)
    v_mul_f32 v8, v8, v10
    v_cvt_pk_bf16_f32 v8, v8, v8
    v_and_b32 v8, s51, v8
    v_add_f32 v8, v8, v104
    v_cvt_pk_bf16_f32 v8, v8, v8
    s_mov_b32 exec_lo, 15
    s_mov_b32 exec_hi, 15
    global_store_short v105, v8, s[26:27]
L_end:
L_exit:
    s_endpgm
.section .rodata,"a"
.p2align 6
.amdhsa_kernel recurrent_scan__gqa_block_cached__glu_gated_reglu__decode_kernel
  .amdhsa_next_free_vgpr 240
  .amdhsa_next_free_sgpr 100
  .amdhsa_accum_offset 240
  .amdhsa_group_segment_fixed_size 0
  .amdhsa_kernarg_size 96
  .amdhsa_user_sgpr_count 2
  .amdhsa_user_sgpr_kernarg_segment_ptr 1
  .amdhsa_system_sgpr_workgroup_id_x 1
  .amdhsa_float_denorm_mode_32 3
.end_amdhsa_kernel
```
